```python
import torch

def _softmax(x, axis=-1):
    return torch.softmax(x, dim=axis)
def _gelu(x):
    return torch.nn.functional.gelu(x, approximate="tanh")
def _silu(x):
    return torch.nn.functional.silu(x)
def _sigmoid(x):
    return torch.sigmoid(x)
def _layernorm(x, axis=-1, eps=1e-5):
    m = x.mean(dim=axis, keepdim=True)
    v = x.var(dim=axis, keepdim=True, unbiased=False)
    return (x - m) / torch.sqrt(v + eps)
def _scatter_add(tgt, idx, src, axis=0):
    return tgt.clone().index_add_(axis, idx, src)
def _segment_sum(src, seg, n):
    out = torch.zeros((n,) + src.shape[1:], dtype=src.dtype)
    return out.index_add_(0, seg, src)
def _pad(x, pw):
    flat = tuple(v for pair in reversed(pw) for v in pair)
    return torch.nn.functional.pad(x, flat)

kernel_name = 'standalone__kernel_systems_refs_featgraph__graph'

def setup_inputs():

    _w = (lambda a: (lambda t: t.to(torch.bfloat16) if t.is_floating_point() else t)(torch.as_tensor(a)))
    N, deg, D = 10000, 16, 256
    E = N * deg
    scale = D ** -0.5
    src = (lambda lo, hi, *s: torch.randint(lo, hi, s))(0, N, E).to(torch.int64)
    dst = (lambda lo, hi, *s: torch.randint(lo, hi, s))(0, N, E).to(torch.int64)
    return {
        "x": _w((lambda *s: torch.randn(*s, dtype=torch.bfloat16) * 0.8)(N, D)),
        "src": _w(src),
        "dst": _w(dst),
        "w_q": _w((lambda *s: torch.randn(*s, dtype=torch.bfloat16) * 0.8)(D, D) * scale),
        "w_v": _w((lambda *s: torch.randn(*s, dtype=torch.bfloat16) * 0.05)(D, D) * scale),
    }

def reference(x, src, dst, w_q, w_v):
    N, D = x.shape
    xs = x[src]
    xd = x[dst]
    q = xd @ w_q
    logits = torch.einsum('ed,ed->e', xs, q) * (float(D) ** -0.5)
    alpha = _sigmoid(logits)
    msg = alpha[:, None] * (xs @ w_v)
    return _segment_sum(msg, dst, N)
```

```asm
; @launch grid=(256,1,1) block=(512,1,1) lds=163840
.amdgcn_target "amdgcn-amd-amdhsa--gfx950"
.text
.globl standalone__kernel_systems_refs_featgraph__graph_kernel
.p2align 8
.type standalone__kernel_systems_refs_featgraph__graph_kernel,@function
standalone__kernel_systems_refs_featgraph__graph_kernel:
    s_load_dwordx16 s[4:19], s[0:1], 0
    v_readfirstlane_b32 s36, v0
    s_cmpk_ge_u32 s2, 256
    s_cbranch_scc1 K_done
    v_and_b32 v1, 63, v0
    s_lshr_b32 s36, s36, 6
    s_and_b32 s93, s36, 3
    s_lshl_b32 s54, s93, 15
    s_addk_i32 s54, 2048
    s_cmp_lt_u32 s36, 4
    s_cbranch_scc0 C_head
L_head:
    s_cmp_ge_u32 s2, 125
    s_cbranch_scc1 L_cons
    s_mul_i32 s3, s2, 5120
    v_lshl_add_u32 v116, v0, 4, s3
    s_add_u32 s3, s3, 4096
    v_lshl_add_u32 v117, v0, 2, s3
    s_waitcnt lgkmcnt(0)
    global_load_dwordx4 v[52:55], v116, s[8:9]
    global_load_dword v56, v117, s[8:9]
    global_load_dwordx4 v[60:63], v116, s[6:7]
    global_load_dword v64, v117, s[6:7]
    s_branch L_img
L_cons:
    s_cmp_lg_u32 s36, 0
    s_cbranch_scc1 L_wait
    s_getpc_b64 s[60:61]
    s_and_b32 s3, s2, 0x78
    s_lshl_b32 s3, s3, KC_4-KC_Z
    v_lshl_add_u32 v230, v1, 11, s3
    v_cmpx_gt_u32 vcc, K_done-L_img, v230
    global_load_dword v9, v230, s[60:61]
    s_mov_b32 exec_lo, 0xffff0000
    s_mov_b32 exec_hi, 0xffffffff
    s_waitcnt lgkmcnt(0)
    global_load_dword v9, v230, s[10:11]
    s_mov_b32 exec_lo, 0xffffff
    s_mov_b32 exec_hi, 0x0
    global_load_dword v9, v230, s[12:13]
    s_mov_b64 exec, -1
L_wait:
    s_waitcnt lgkmcnt(0)
    s_branch L_setup
    s_nop 0
L_img:
    s_add_u32 s60, s18, 4194304
    s_addc_u32 s61, s19, 0
    s_load_dwordx2 s[52:53], s[60:61], 0
    s_load_dwordx2 s[28:29], s[8:9], 0
    s_load_dwordx2 s[30:31], s[6:7], 0
    v_lshlrev_b32 v118, 4, v0
    v_bfrev_b32 v68, 1
    v_mov_b32 v69, v68
    v_mov_b32 v70, v68
    v_mov_b32_e64 v71, v68
    ds_write_b128 v118, v[68:71] offset:18432
    v_or_b32 v72, 1, v68
    v_mov_b32 v73, v72
    v_mov_b32 v74, v72
    v_mov_b32 v75, v72
    ds_write_b128 v118, v[72:75] offset:22528
    v_or_b32 v76, 2, v68
    v_mov_b32 v77, v76
    v_mov_b32 v78, v76
    v_mov_b32 v79, v76
    ds_write_b128 v118, v[76:79] offset:26624
    v_or_b32 v80, 3, v68
    v_mov_b32 v81, v80
    v_mov_b32 v82, v80
    v_mov_b32 v83, v80
    ds_write_b128 v118, v[80:83] offset:30720
    v_lshlrev_b32 v232, 2, v0
    v_lshlrev_b32 v233, 6, v0
    v_mov_b32_e64 v121, 0
    ds_write_b32 v232, v233 offset:1024
    ds_write_b32 v121, v121 offset:32
    s_branch L_setup2
L_setup:
    s_add_u32 s60, s18, 4194304
    s_addc_u32 s61, s19, 0
    s_load_dwordx2 s[52:53], s[60:61], 0
    s_load_dwordx2 s[28:29], s[8:9], 0
    s_load_dwordx2 s[30:31], s[6:7], 0
L_setup2:
    v_mov_b32_e64 v3, 4
    s_mul_i32 s3, s2, 16384
    s_add_u32 s3, s3, 4096
    v_lshl_add_u32 v119, v0, 4, s3
    v_add_u32 v120, 8192, v119
    s_mov_b32 s62, 2139095299
    s_sub_u32 s40, s10, 3072
    s_subb_u32 s41, s11, 0
    s_mov_b32 s42, 134144
    s_mov_b32 s43, 0x20000
    v_lshrrev_b32 v230, 3, v1
    v_bitop3_b32 v231, v230, 6, v1 bitop3:0x6a
    v_and_b32 v231, 7, v231
    s_lshl_b32 s3, s93, 7
    v_lshl_add_u32 v231, v231, 4, s3
    v_and_b32 v229, 4, v230
    v_add_u32 v230, v229, v230
    v_lshl_add_u32 v229, v230, 9, v231
    s_waitcnt lgkmcnt(0)
    s_add_u32 s52, s52, 0x9e3779b9
    s_add_u32 s53, s53, 0x7f4a7c15
    s_pack_ll_b32_b16 s28, s28, s29
    s_pack_ll_b32_b16 s30, s30, s31
    s_mul_i32 s28, s28, 0x85ebca77
    s_mul_i32 s30, s30, 0xc2b2ae3d
    s_add_u32 s52, s52, s28
    s_add_u32 s53, s53, s30
    s_cmp_ge_u32 s2, 125
    s_cbranch_scc1 L_published
    s_barrier
    s_waitcnt vmcnt(2)
    v_mul_u32_u24_sdwa v84, v3, v52 dst_sel:DWORD dst_unused:UNUSED_PAD src0_sel:DWORD src1_sel:BYTE_0
    ds_add_rtn_u32 v92, v84, v3 offset:1024
    v_mul_u32_u24_sdwa v85, v3, v53 dst_sel:DWORD dst_unused:UNUSED_PAD src0_sel:DWORD src1_sel:BYTE_0
    ds_add_rtn_u32 v93, v85, v3 offset:1024
    v_mul_u32_u24_sdwa v86, v3, v54 dst_sel:DWORD dst_unused:UNUSED_PAD src0_sel:DWORD src1_sel:BYTE_0
    ds_add_rtn_u32 v94, v86, v3 offset:1024
    v_mul_u32_u24_sdwa v87, v3, v55 dst_sel:DWORD dst_unused:UNUSED_PAD src0_sel:DWORD src1_sel:BYTE_0
    ds_add_rtn_u32 v95, v87, v3 offset:1024
    v_mul_u32_u24_sdwa v88, v3, v56 dst_sel:DWORD dst_unused:UNUSED_PAD src0_sel:DWORD src1_sel:BYTE_0
    ds_add_rtn_u32 v96, v88, v3 offset:1024
    v_lshrrev_b32_e64 v52, 6, v52
    v_lshl_add_u32 v84, v84, 4, 60
    v_lshrrev_b32_e64 v53, 6, v53
    v_lshl_add_u32 v85, v85, 4, 60
    v_lshrrev_b32_e64 v54, 6, v54
    v_lshl_add_u32 v86, v86, 4, 60
    v_lshrrev_b32_e64 v55, 6, v55
    v_lshl_add_u32 v87, v87, 4, 60
    v_lshrrev_b32_e64 v56, 6, v56
    v_lshl_add_u32 v88, v88, 4, 60
    s_brev_b32 s61, 1
    s_waitcnt vmcnt(0)
    v_lshl_or_b32 v52, v60, 9, v52
    s_waitcnt lgkmcnt(4)
    v_sub_u32 v60, v84, v92
    v_and_or_b32 v92, v60, s61, v92
    ds_write_b32 v92, v52 offset:18432
    v_lshl_or_b32 v53, v61, 9, v53
    s_waitcnt lgkmcnt(4)
    v_sub_u32 v61, v85, v93
    v_and_or_b32 v93, v61, s61, v93
    ds_write_b32 v93, v53 offset:18432
    v_lshl_or_b32 v54, v62, 9, v54
    s_waitcnt lgkmcnt(4)
    v_sub_u32 v62, v86, v94
    v_and_or_b32 v94, v62, s61, v94
    ds_write_b32 v94, v54 offset:18432
    v_lshl_or_b32 v55, v63, 9, v55
    s_waitcnt lgkmcnt(4)
    v_sub_u32 v63, v87, v95
    v_and_or_b32 v95, v63, s61, v95
    ds_write_b32 v95, v55 offset:18432
    v_lshl_or_b32 v56, v64, 9, v56
    s_waitcnt lgkmcnt(4)
    v_sub_u32 v64, v88, v96
    v_and_or_b32 v96, v64, s61, v96
    ds_write_b32 v96, v56 offset:18432
    v_or3_b32 v121, v60, v61, v62
    v_or3_b32 v121, v121, v63, v64
    v_cmp_gt_i32 vcc, 0, v121
    s_cbranch_vccnz L_spill
L_spilled:
    s_waitcnt lgkmcnt(0)
    s_barrier
    ds_read_b32 v121, v3 offset:28
    ds_read_b128 v[100:103], v118 offset:18432
    ds_read_b128 v[104:107], v118 offset:22528
    ds_read_b128 v[108:111], v118 offset:26624
    ds_read_b128 v[112:115], v118 offset:30720
    s_and_b32 s28, s52, s62
    s_lshl_b32 s3, s52, 12
    s_lshr_b32 s60, s52, 20
    s_or_b32 s3, s3, s60
    s_and_b32 s29, s3, s62
    s_and_b32 s30, s53, s62
    s_lshl_b32 s3, s53, 12
    s_lshr_b32 s60, s53, 20
    s_or_b32 s3, s3, s60
    s_and_b32 s31, s3, s62
    s_waitcnt lgkmcnt(3)
    v_readfirstlane_b32 s3, v121
    s_cmp_lg_u32 s3, 0
    s_cbranch_scc1 L_overflow
L_publish:
    v_xor_b32 v100, s28, v100
    v_xor_b32 v101, s29, v101
    v_xor_b32 v102, s30, v102
    v_xor_b32 v103, s31, v103
    global_store_dwordx4 v119, v[100:103], s[18:19] offset:-4096 sc1
    s_waitcnt lgkmcnt(2)
    v_xor_b32 v104, s28, v104
    v_xor_b32 v105, s29, v105
    v_xor_b32 v106, s30, v106
    v_xor_b32_e64 v107, s31, v107
    global_store_dwordx4 v119, v[104:107], s[18:19] offset:0 sc1
    s_waitcnt lgkmcnt(1)
    v_xor_b32 v108, s28, v108
    v_xor_b32 v109, s29, v109
    v_xor_b32 v110, s30, v110
    v_xor_b32_e64 v111, s31, v111
    global_store_dwordx4 v120, v[108:111], s[18:19] offset:-4096 sc1
    s_waitcnt lgkmcnt(0)
    v_xor_b32 v112, s28, v112
    v_xor_b32 v113, s29, v113
    v_xor_b32 v114, s30, v114
    v_xor_b32_e64 v115, s31, v115
    global_store_dwordx4 v120, v[112:115], s[18:19] offset:0 sc1
    s_barrier
L_published:
    s_and_b32 s3, s2, 7
    s_bfe_u32 s56, s2, 0x40003
    s_lshl4_add_u32 s3, s3, s56
    s_lshr_b32 s56, s2, KC_7-KC_Z
    s_lshl1_add_u32 s56, s3, s56
    s_mov_b32 s22, 5123072
    s_mov_b32 s23, 0x20000
    s_mov_b32 s39, 640000
    s_mov_b32 s63, KC_0-KC_Z
    s_sub_u32 s20, s4, 3072
    s_subb_u32 s21, s5, 0
    s_lshl_b32 s3, s56, 6
    v_lshrrev_b32 v230, 2, v0
    v_and_b32 v231, 3, v0
    v_lshl_add_u32 v231, v231, 4, s3
    v_mul_u32_u24 v36, 16384, v230
    v_add_u32_e64 v36, v36, v231
    v_add_u32 v37, 1048576, v36
    v_cmp_gt_u32 s[50:51], 61, v230
    s_mov_b64 s[48:49], -1
    v_bfrev_b32 v24, 1
    v_bfrev_b32 v25, 1
    v_bfrev_b32 v26, 1
    v_bfrev_b32 v27, 1
    s_lshr_b32 s3, s2, 3
    s_lshl_b32 s3, s3, 2
    s_add_u32 s3, s3, s93
    s_mul_i32 s60, s3, 4608
    v_lshl_add_u32 v8, v1, 7, s60
    s_lshl_b32 s3, s3, 10
    v_and_b32 v233, 7, v1
    v_lshl_add_u32 v7, v233, 7, s3
    s_and_b32 s28, s52, s62
    s_lshl_b32 s3, s52, 12
    s_lshr_b32 s60, s52, 20
    s_or_b32 s3, s3, s60
    s_and_b32 s29, s3, s62
    s_and_b32 s30, s53, s62
    s_lshl_b32 s3, s53, 12
    s_lshr_b32 s60, s53, 20
    s_or_b32 s3, s3, s60
    s_and_b32 s31, s3, s62
    s_lshr_b32 s3, s56, 6
    s_xor_b32 s28, s28, s3
    s_xor_b32 s29, s29, s3
    s_xor_b32 s30, s30, s3
    s_xor_b32 s31, s31, s3
    s_mov_b64 s[24:25], s[12:13]
    s_mov_b32 s26, 0x20000
    s_mov_b32 s27, 0x20000
    s_movk_i32 s88, 1024
    s_movk_i32 s89, 2048
    s_movk_i32 s90, 3072
    s_mov_b32 s91, 0
    v_and_b32 v230, 31, v1
    v_lshlrev_b32 v204, 4, v230
    v_lshlrev_b32 v4, 2, v1
    v_mul_u32_u24 v252, 2016, v1
    v_add_u32 v252, 155588, v252
    s_mov_b32 s55, 0x7ffe00
    s_mov_b64 s[32:33], s[14:15]
    s_mov_b32 s34, 5120000
    s_mov_b32 s35, 0x20000
    s_mov_b32 s94, 0x05040100
    s_mov_b32 s95, 0x07060302
    s_mov_b32 s96, 0xff00ff00
    s_mov_b32 s97, 0xff00ff00
    v_xor_b32 v205, 32, v204
    v_xor_b32 v206, 64, v204
    v_xor_b32 v207, 96, v204
    v_xor_b32 v208, 128, v204
    v_xor_b32 v209, 160, v204
    v_xor_b32 v210, 192, v204
    v_xor_b32 v211, 224, v204
    s_mul_i32 s3, s93, 2016
    s_add_u32 s3, s3, 155648
    v_and_b32 v6, 32, v1
    v_add_u32 v228, s3, v6
    v_and_b32 v230, 15, v1
    v_lshrrev_b32 v231, 4, v1
    v_and_b32 v232, 7, v1
    v_lshlrev_b32 v232, 1, v232
    v_xor_b32 v232, v232, v231
    v_lshlrev_b32 v232, 4, v232
    v_lshl_add_u32 v10, v230, 9, v232
    v_add_u32 v10, 133120, v10
    v_xor_b32_e64 v11, 64, v10
    v_xor_b32 v12, 0x80, v10
    v_xor_b32 v13, 0xc0, v10
    v_bfe_u32 v232, v1, 3, 1
    v_lshl_add_u32 v230, v231, 2, v232
    v_lshl_add_u32 v232, v232, 2, v231
    s_lshl_b32 s60, s93, KC_7-KC_Z
    v_lshl_add_u32 v2, v233, 4, s60
    s_lshl_b32 s3, s56, 9
    v_add_u32 v231, s3, v2
    v_lshl_add_u32 v2, v232, 11, v2
    v_add_u32 v232, 0, v230
    v_mul_u32_u24 v233, 26, v232
    v_lshrrev_b32_e64 v233, 8, v233
    v_mad_i32_i24 v232, v233, -10, v232
    v_lshl_add_u32 v232, v232, 2, v233
    v_lshl_add_u32 v14, v232, 17, v231
    v_add_u32 v232, 2, v230
    v_mul_u32_u24 v233, 26, v232
    v_lshrrev_b32_e64 v233, 8, v233
    v_mad_i32_i24 v232, v233, -10, v232
    v_lshl_add_u32 v232, v232, 2, v233
    v_lshl_add_u32 v15, v232, 17, v231
    v_add_u32 v232, 16, v230
    v_mul_u32_u24 v233, 26, v232
    v_lshrrev_b32_e64 v233, 8, v233
    v_mad_i32_i24 v232, v233, -10, v232
    v_lshl_add_u32 v232, v232, 2, v233
    v_lshl_add_u32 v16, v232, 17, v231
    v_add_u32 v232, 18, v230
    v_mul_u32_u24 v233, 26, v232
    v_lshrrev_b32_e64 v233, 8, v233
    v_mad_i32_i24 v232, v233, -10, v232
    v_lshl_add_u32 v232, v232, 2, v233
    v_lshl_add_u32 v17, v232, 17, v231
    v_add_u32 v232, 32, v230
    v_mul_u32_u24 v233, 26, v232
    v_lshrrev_b32_e64 v233, 8, v233
    v_mad_i32_i24 v232, v233, -10, v232
    v_lshl_add_u32 v232, v232, 2, v233
    v_lshl_add_u32 v18, v232, 17, v231
    v_add_u32 v232, 34, v230
    v_mul_u32_u24 v233, 26, v232
    v_lshrrev_b32_e64 v233, 8, v233
    v_mad_i32_i24 v232, v233, -10, v232
    v_lshl_add_u32 v232, v232, 2, v233
    v_lshl_add_u32 v19, v232, 17, v231
    s_mov_b32 s60, 0x8000000c
    s_brev_b32 s61, 1
    s_mov_b32 s3, KC_0-KC_Z
    s_barrier
    s_add_u32 m0, s54, 16384
    s_mov_b32 s99, 68608
    buffer_load_dwordx4 v229, s[40:43], s99 offen offset:0 lds
    s_mov_b32 s99, 75776
    buffer_load_dwordx4 v229, s[40:43], s99 offen offset:1024 lds
    s_mov_b32 s99, 68608
    buffer_load_dwordx4 v229, s[40:43], s99 offen offset:2048 lds
    s_mov_b32 s99, 75776
    buffer_load_dwordx4 v229, s[40:43], s99 offen offset:3072 lds
    s_add_u32 m0, s54, 20480
    s_mov_b32 s99, 84992
    buffer_load_dwordx4 v229, s[40:43], s99 offen offset:0 lds
    s_mov_b32 s99, 92160
    buffer_load_dwordx4 v229, s[40:43], s99 offen offset:1024 lds
    s_mov_b32 s99, 84992
    buffer_load_dwordx4 v229, s[40:43], s99 offen offset:2048 lds
    s_mov_b32 s99, 92160
    buffer_load_dwordx4 v229, s[40:43], s99 offen offset:3072 lds
    s_add_u32 m0, s54, 24576
    s_mov_b32 s99, 101376
    buffer_load_dwordx4 v229, s[40:43], s99 offen offset:0 lds
    s_mov_b32 s99, 108544
    buffer_load_dwordx4 v229, s[40:43], s99 offen offset:1024 lds
    s_mov_b32 s99, 101376
    buffer_load_dwordx4 v229, s[40:43], s99 offen offset:2048 lds
    s_mov_b32 s99, 108544
    buffer_load_dwordx4 v229, s[40:43], s99 offen offset:3072 lds
    s_add_u32 m0, s54, 28672
    s_mov_b32 s99, 117760
    buffer_load_dwordx4 v229, s[40:43], s99 offen offset:0 lds
    s_mov_b32 s99, 124928
    buffer_load_dwordx4 v229, s[40:43], s99 offen offset:1024 lds
    s_mov_b32 s99, 117760
    buffer_load_dwordx4 v229, s[40:43], s99 offen offset:2048 lds
    s_mov_b32 s99, 124928
    buffer_load_dwordx4 v229, s[40:43], s99 offen offset:3072 lds
    global_load_dwordx4 v[20:23], v36, s[18:19] sc1
    s_mov_b64 exec, s[50:51]
    global_load_dwordx4 v[24:27], v37, s[18:19] sc1
    s_mov_b64 exec, -1
    s_mov_b32 s45, KC_0-KC_Z
    buffer_load_dwordx4 v[68:71], v2, s[24:27], s45 offen offset:0
    buffer_load_dwordx4 v[72:75], v2, s[24:27], s45 offen offset:512
    buffer_load_dwordx4 v[76:79], v2, s[24:27], s45 offen offset:1024
    buffer_load_dwordx4 v[80:83], v2, s[24:27], s45 offen offset:1536
    s_mov_b32 s45, 16384
    buffer_load_dwordx4 v[84:87], v2, s[24:27], s45 offen offset:0
    buffer_load_dwordx4 v[88:91], v2, s[24:27], s45 offen offset:512
    s_waitcnt vmcnt(8)
    s_barrier
    s_mov_b32 exec_hi, 0xf
    buffer_load_dword v9, v8, s[20:23], s90 offen
    s_mov_b64 exec, -1
    s_waitcnt vmcnt(7)
L_poll:
    s_mov_b64 exec, s[48:49]
    v_xor_b32 v20, s28, v20
    v_xor_b32 v21, s29, v21
    v_xor_b32 v22, s30, v22
    v_xor_b32 v23, s31, v23
    v_or3_b32 v28, v20, v21, v22
    v_bitop3_b32 v28, v28, v23, s62 bitop3:0xa8
    v_cmp_ne_u32 s[48:49], 0, v28
    s_mov_b64 exec, s[50:51]
    v_xor_b32 v24, s28, v24
    v_xor_b32 v25, s29, v25
    v_xor_b32 v26, s30, v26
    v_xor_b32_e64 v27, s31, v27
    v_or3_b32 v29, v24, v25, v26
    v_bitop3_b32 v29, v29, v27, s62 bitop3:0xa8
    v_cmp_ne_u32 s[50:51], 0, v29
    s_mov_b64 exec, -1
    s_or_b64 vcc, s[48:49], s[50:51]
    s_cbranch_scc1 L_repoll
L_polled:
    v_and_b32 v28, s60, v20
    ds_add_rtn_u32 v28, v28, v3
    v_and_b32_e64 v29, s60, v21
    ds_add_rtn_u32 v29, v29, v3
    v_and_b32_e64 v30, s60, v22
    ds_add_rtn_u32 v30, v30, v3
    v_and_b32_e64 v31, s60, v23
    ds_add_rtn_u32 v31, v31, v3
    v_and_b32_e64 v32, s60, v24
    ds_add_rtn_u32 v32, v32, v3
    v_and_b32_e64 v33, s60, v25
    ds_add_rtn_u32 v33, v33, v3
    v_and_b32_e64 v34, s60, v26
    ds_add_rtn_u32 v34, v34, v3
    v_and_b32_e64 v35, s60, v27
    ds_add_rtn_u32 v35, v35, v3
    buffer_load_dwordx4 v[92:95], v2, s[24:27], s45 offen offset:1024
    buffer_load_dwordx4 v[96:99], v2, s[24:27], s45 offen offset:1536
    s_mov_b32 s45, 32768
    buffer_load_dwordx4 v[100:103], v2, s[24:27], s45 offen offset:0
    buffer_load_dwordx4 v[104:107], v2, s[24:27], s45 offen offset:512
    buffer_load_dwordx4 v[108:111], v2, s[24:27], s45 offen offset:1024
    buffer_load_dwordx4 v[112:115], v2, s[24:27], s45 offen offset:1536
    s_waitcnt lgkmcnt(7)
    v_and_or_b32 v28, v20, s61, v28
    ds_write_b32 v28, v20
    s_waitcnt lgkmcnt(7)
    v_and_or_b32 v29, v21, s61, v29
    ds_write_b32 v29, v21
    s_waitcnt lgkmcnt(7)
    v_and_or_b32 v30, v22, s61, v30
    ds_write_b32 v30, v22
    s_waitcnt lgkmcnt(7)
    v_and_or_b32 v31, v23, s61, v31
    ds_write_b32 v31, v23
    s_waitcnt lgkmcnt(7)
    v_and_or_b32 v32, v24, s61, v32
    ds_write_b32 v32, v24
    s_waitcnt lgkmcnt(7)
    v_and_or_b32 v33, v25, s61, v33
    ds_write_b32 v33, v25
    s_waitcnt lgkmcnt(7)
    v_and_or_b32 v34, v26, s61, v34
    ds_write_b32 v34, v26
    s_waitcnt lgkmcnt(7)
    v_and_or_b32 v35, v27, s61, v35
    ds_write_b32 v35, v27
    s_add_u32 s3, s61, KC_4-KC_Z
    v_cmp_eq_u32 s[40:41], s3, v20
    v_cmp_eq_u32 s[42:43], s3, v24
    s_or_b64 vcc, s[40:41], s[42:43]
    s_cbranch_scc1 L_mark
L_marked:
    s_waitcnt lgkmcnt(0)
    s_barrier
L_lists:
    ds_read_b32 v5, v4
    ds_read_b128 v[212:215], v228 offset:0
    ds_read_b128 v[216:219], v228 offset:16
    s_add_u32 m0, s54, 0x4000
    s_waitcnt lgkmcnt(0)
    v_readlane_b32 s3, v5, 4
    v_and_or_b32 v212, v212, s55, v204
    s_cmp_lg_u32 s3, s91
    s_cbranch_scc1 L_rescan
    buffer_load_dwordx4 v212, s[20:23], s90 offen offset:0 lds
    v_and_or_b32 v213, v213, s55, v205
    v_sub_u32 v6, v5, v252
    v_lshrrev_b32 v6, 6, v6
    v_max_u32 v6, 4, v6
    v_readlane_b32 s3, v5, 5
    buffer_load_dwordx4 v213, s[20:23], s89 offen offset:1024 lds
    v_and_or_b32 v214, v214, s55, v206
    v_readlane_b32 s37, v6, s93
    v_readlane_b32 s38, v6, 0
    v_readlane_b32 s60, v6, 1
    v_readlane_b32 s61, v6, 2
    buffer_load_dwordx4 v214, s[20:23], s88 offen offset:2048 lds
    v_and_or_b32 v215, v215, s55, v207
    s_or_b32 s63, s63, s3
    s_max_u32 s38, s38, s60
    v_readlane_b32 s60, v6, 3
    s_max_u32 s38, s38, s61
    buffer_load_dwordx4 v215, s[20:23], 0 offen offset:3072 lds
    v_and_or_b32 v216, v216, s55, v208
    s_lshl_b32 s3, s3, KC_8-KC_Z
    s_max_u32 s38, s38, s60
    s_or_b32 s3, s3, s38
    s_sub_u32 s44, s38, s37
    s_cmp_ge_u32 s44, 1
    s_cbranch_scc1 L_xpre
L_xback:
    s_addk_i32 m0, 0x1000
    s_nop 0
    buffer_load_dwordx4 v216, s[20:23], s90 offen offset:0 lds
    v_and_or_b32 v217, v217, s55, v209
    s_lshl_b32 s60, s37, KC_6-KC_Z
    s_sub_u32 s60, s60, 1024
    v_add_u32_e64 v228, s60, v228
    buffer_load_dwordx4 v217, s[20:23], s89 offen offset:1024 lds
    v_and_or_b32 v218, v218, s55, v210
    ds_read_b128 v[220:223], v228 offset:960
    ds_read_b128 v[224:227], v228 offset:976
    s_sub_u32 s59, s38, s37
    buffer_load_dwordx4 v218, s[20:23], s88 offen offset:2048 lds
    v_and_or_b32 v219, v219, s55, v211
    s_sub_u32 s58, s37, 3
    s_mov_b32 s92, 8192
    buffer_load_dwordx4 v219, s[20:23], 0 offen offset:3072 lds
    ds_read_b128 v[212:215], v228 offset:896
    ds_read_b128 v[216:219], v228 offset:912
    s_addk_i32 m0, 0x1000
    s_cmp_gt_u32 s3, 30
    s_cbranch_scc1 L_goslow
    s_waitcnt lgkmcnt(2)
    v_and_or_b32 v220, v220, s55, v204
    s_cmp_lt_u32 s59, 1
    s_cbranch_scc1 L_g1
    s_barrier
    s_sub_u32 s59, s59, 1
L_g1:
    buffer_load_dwordx4 v220, s[20:23], s90 offen offset:0 lds
    v_and_or_b32 v221, v221, s55, v205
    buffer_load_dwordx4 v221, s[20:23], s89 offen offset:1024 lds
    v_and_or_b32 v222, v222, s55, v206
    buffer_load_dwordx4 v222, s[20:23], s88 offen offset:2048 lds
    v_and_or_b32 v223, v223, s55, v207
    buffer_load_dwordx4 v223, s[20:23], 0 offen offset:3072 lds
    v_and_or_b32 v224, v224, s55, v208
    s_add_u32 m0, m0, 0x1000
    s_nop 0
    buffer_load_dwordx4 v224, s[20:23], s90 offen offset:0 lds
    v_and_or_b32 v225, v225, s55, v209
    buffer_load_dwordx4 v225, s[20:23], s89 offen offset:1024 lds
    v_and_or_b32 v226, v226, s55, v210
    buffer_load_dwordx4 v226, s[20:23], s88 offen offset:2048 lds
    v_and_or_b32 v227, v227, s55, v211
    buffer_load_dwordx4 v227, s[20:23], 0 offen offset:3072 lds
    s_waitcnt lgkmcnt(0)
    v_and_or_b32 v212, v212, s55, v204
    v_and_or_b32 v213, v213, s55, v205
    v_and_or_b32 v214, v214, s55, v206
    v_and_or_b32 v215, v215, s55, v207
    v_and_or_b32 v216, v216, s55, v208
    v_and_or_b32 v217, v217, s55, v209
    v_and_or_b32 v218, v218, s55, v210
    v_and_or_b32 v219, v219, s55, v211
    s_mov_b32 m0, s54
    s_cmp_eq_u32 s59, 0
    s_cbranch_scc1 L_g2
    s_barrier
    s_sub_u32 s59, s59, KC_1-KC_Z
L_g2:
    ds_read_b128 v[220:223], v228 offset:832
    buffer_load_dwordx4 v212, s[20:23], s90 offen offset:0 lds
    buffer_load_dwordx4 v213, s[20:23], s89 offen offset:1024 lds
    buffer_load_dwordx4 v214, s[20:23], s88 offen offset:2048 lds
    buffer_load_dwordx4 v215, s[20:23], 0 offen offset:3072 lds
    s_addk_i32 m0, 0x1000
    s_waitcnt lgkmcnt(0)
    v_and_or_b32 v212, v220, s55, v204
    v_and_or_b32 v213, v221, s55, v205
    v_and_or_b32 v214, v222, s55, v206
    v_and_or_b32 v215, v223, s55, v207
    s_cmp_ge_u32 s44, 1
    s_cbranch_scc1 L_xdone
    s_waitcnt vmcnt(20)
    s_branch L_xa
L_xpre:
    s_waitcnt vmcnt(4)
L_xa:
    s_mov_b64 vcc, s[96:97]
    v_cndmask_b32_dpp v196, v68, v70, vcc row_ror:8 row_mask:0xf bank_mask:0xf
    v_mov_b32_dpp v68, v70 row_ror:8 row_mask:0xf bank_mask:0xc
    v_cndmask_b32_dpp v197, v72, v74, vcc row_ror:8 row_mask:0xf bank_mask:0xf
    v_mov_b32_dpp v72, v74 row_ror:8 row_mask:0xf bank_mask:0xc
    v_cndmask_b32_dpp v198, v76, v78, vcc row_ror:8 row_mask:0xf bank_mask:0xf
    v_mov_b32_dpp v76, v78 row_ror:8 row_mask:0xf bank_mask:0xc
    v_cndmask_b32_dpp v199, v80, v82, vcc row_ror:8 row_mask:0xf bank_mask:0xf
    v_mov_b32_dpp v80, v82 row_ror:8 row_mask:0xf bank_mask:0xc
    v_cndmask_b32_dpp v200, v69, v71, vcc row_ror:8 row_mask:0xf bank_mask:0xf
    v_mov_b32_dpp v69, v71 row_ror:8 row_mask:0xf bank_mask:0xc
    v_cndmask_b32_dpp v201, v73, v75, vcc row_ror:8 row_mask:0xf bank_mask:0xf
    v_mov_b32_dpp v73, v75 row_ror:8 row_mask:0xf bank_mask:0xc
    v_cndmask_b32_dpp v202, v77, v79, vcc row_ror:8 row_mask:0xf bank_mask:0xf
    v_mov_b32_dpp v77, v79 row_ror:8 row_mask:0xf bank_mask:0xc
    v_cndmask_b32_dpp v203, v81, v83, vcc row_ror:8 row_mask:0xf bank_mask:0xf
    v_mov_b32_dpp v81, v83 row_ror:8 row_mask:0xf bank_mask:0xc
    v_perm_b32 v52, v72, v68, s94
    v_perm_b32 v53, v80, v76, s94
    v_perm_b32 v54, v197, v196, s94
    v_perm_b32 v55, v199, v198, s94
    v_perm_b32 v56, v72, v68, s95
    v_perm_b32 v57, v80, v76, s95
    v_perm_b32 v58, v197, v196, s95
    v_perm_b32 v59, v199, v198, s95
    v_perm_b32 v60, v73, v69, s94
    v_perm_b32 v61, v81, v77, s94
    v_perm_b32 v62, v201, v200, s94
    v_perm_b32 v63, v203, v202, s94
    v_perm_b32 v64, v73, v69, s95
    v_perm_b32 v65, v81, v77, s95
    v_perm_b32 v66, v201, v200, s95
    v_perm_b32 v67, v203, v202, s95
    s_mov_b64 vcc, s[96:97]
    v_cndmask_b32_dpp v196, v84, v86, vcc row_ror:8 row_mask:0xf bank_mask:0xf
    v_mov_b32_dpp v84, v86 row_ror:8 row_mask:0xf bank_mask:0xc
    v_cndmask_b32_dpp v197, v88, v90, vcc row_ror:8 row_mask:0xf bank_mask:0xf
    v_mov_b32_dpp v88, v90 row_ror:8 row_mask:0xf bank_mask:0xc
    v_cndmask_b32_dpp v198, v92, v94, vcc row_ror:8 row_mask:0xf bank_mask:0xf
    v_mov_b32_dpp v92, v94 row_ror:8 row_mask:0xf bank_mask:0xc
    v_cndmask_b32_dpp v199, v96, v98, vcc row_ror:8 row_mask:0xf bank_mask:0xf
    v_mov_b32_dpp v96, v98 row_ror:8 row_mask:0xf bank_mask:0xc
    v_cndmask_b32_dpp v200, v85, v87, vcc row_ror:8 row_mask:0xf bank_mask:0xf
    v_mov_b32_dpp v85, v87 row_ror:8 row_mask:0xf bank_mask:0xc
    v_cndmask_b32_dpp v201, v89, v91, vcc row_ror:8 row_mask:0xf bank_mask:0xf
    v_mov_b32_dpp v89, v91 row_ror:8 row_mask:0xf bank_mask:0xc
    v_cndmask_b32_dpp v202, v93, v95, vcc row_ror:8 row_mask:0xf bank_mask:0xf
    v_mov_b32_dpp v93, v95 row_ror:8 row_mask:0xf bank_mask:0xc
    v_cndmask_b32_dpp v203, v97, v99, vcc row_ror:8 row_mask:0xf bank_mask:0xf
    v_mov_b32_dpp v97, v99 row_ror:8 row_mask:0xf bank_mask:0xc
    v_perm_b32 v68, v88, v84, s94
    v_perm_b32 v69, v96, v92, s94
    v_perm_b32 v70, v197, v196, s94
    v_perm_b32 v71, v199, v198, s94
    v_perm_b32 v72, v88, v84, s95
    v_perm_b32 v73, v96, v92, s95
    v_perm_b32 v74, v197, v196, s95
    v_perm_b32 v75, v199, v198, s95
    v_perm_b32 v76, v89, v85, s94
    v_perm_b32 v77, v97, v93, s94
    v_perm_b32 v78, v201, v200, s94
    v_perm_b32 v79, v203, v202, s94
    v_perm_b32 v80, v89, v85, s95
    v_perm_b32 v81, v97, v93, s95
    v_perm_b32 v82, v201, v200, s95
    v_perm_b32 v83, v203, v202, s95
    s_mov_b64 vcc, s[96:97]
    v_cndmask_b32_dpp v196, v100, v102, vcc row_ror:8 row_mask:0xf bank_mask:0xf
    v_mov_b32_dpp v100, v102 row_ror:8 row_mask:0xf bank_mask:0xc
    v_cndmask_b32_dpp v197, v104, v106, vcc row_ror:8 row_mask:0xf bank_mask:0xf
    v_mov_b32_dpp v104, v106 row_ror:8 row_mask:0xf bank_mask:0xc
    v_cndmask_b32_dpp v198, v108, v110, vcc row_ror:8 row_mask:0xf bank_mask:0xf
    v_mov_b32_dpp v108, v110 row_ror:8 row_mask:0xf bank_mask:0xc
    v_cndmask_b32_dpp v199, v112, v114, vcc row_ror:8 row_mask:0xf bank_mask:0xf
    v_mov_b32_dpp v112, v114 row_ror:8 row_mask:0xf bank_mask:0xc
    v_cndmask_b32_dpp v200, v101, v103, vcc row_ror:8 row_mask:0xf bank_mask:0xf
    v_mov_b32_dpp v101, v103 row_ror:8 row_mask:0xf bank_mask:0xc
    v_cndmask_b32_dpp v201, v105, v107, vcc row_ror:8 row_mask:0xf bank_mask:0xf
    v_mov_b32_dpp v105, v107 row_ror:8 row_mask:0xf bank_mask:0xc
    v_cndmask_b32_dpp v202, v109, v111, vcc row_ror:8 row_mask:0xf bank_mask:0xf
    v_mov_b32_dpp v109, v111 row_ror:8 row_mask:0xf bank_mask:0xc
    v_cndmask_b32_dpp v203, v113, v115, vcc row_ror:8 row_mask:0xf bank_mask:0xf
    v_mov_b32_dpp v113, v115 row_ror:8 row_mask:0xf bank_mask:0xc
    v_perm_b32 v84, v104, v100, s94
    v_perm_b32 v85, v112, v108, s94
    v_perm_b32 v86, v197, v196, s94
    v_perm_b32 v87, v199, v198, s94
    v_perm_b32 v88, v104, v100, s95
    v_perm_b32 v89, v112, v108, s95
    v_perm_b32 v90, v197, v196, s95
    v_perm_b32 v91, v199, v198, s95
    v_perm_b32 v92, v105, v101, s94
    v_perm_b32 v93, v113, v109, s94
    v_perm_b32 v94, v201, v200, s94
    v_perm_b32 v95, v203, v202, s94
    v_perm_b32 v96, v105, v101, s95
    v_perm_b32 v97, v113, v109, s95
    v_perm_b32 v98, v201, v200, s95
    v_perm_b32 v99, v203, v202, s95
    s_cmp_ge_u32 s44, 1
    s_cbranch_scc1 L_xback
L_xdone:
    s_waitcnt vmcnt(12)
L_idle:
    s_barrier
    s_sub_u32 s59, s59, 1
    s_cbranch_scc0 L_idle
L_gen:
    ds_read_b128 v[224:227], v228 offset:848
    ds_read_b128 v[220:223], v228 offset:768
    buffer_load_dwordx4 v216, s[20:23], s90 offen offset:0 lds
    buffer_load_dwordx4 v217, s[20:23], s89 offen offset:1024 lds
    buffer_load_dwordx4 v218, s[20:23], s88 offen offset:2048 lds
    buffer_load_dwordx4 v219, s[20:23], 0 offen offset:3072 lds
    s_add_u32 m0, s54, s92
    s_add_u32 s92, s92, 0x1000
    s_and_b32 s92, s92, 0x7000
    s_waitcnt lgkmcnt(0)
    buffer_load_dwordx4 v212, s[20:23], s90 offen offset:0 lds
    v_and_or_b32 v216, v224, s55, v208
    v_and_or_b32 v217, v225, s55, v209
    buffer_load_dwordx4 v213, s[20:23], s89 offen offset:1024 lds
    v_and_or_b32 v218, v226, s55, v210
    v_and_or_b32 v219, v227, s55, v211
    buffer_load_dwordx4 v214, s[20:23], s88 offen offset:2048 lds
    v_and_or_b32 v212, v220, s55, v204
    v_and_or_b32 v213, v221, s55, v205
    v_and_or_b32 v214, v222, s55, v206
    buffer_load_dwordx4 v215, s[20:23], 0 offen offset:3072 lds
    v_and_or_b32 v215, v223, s55, v207
    s_add_u32 m0, s54, s92
    s_add_u32 s92, s92, 0x1000
    s_and_b32 s92, s92, 0x7000
    v_subrev_u32 v228, 64, v228
    s_sub_u32 s58, s58, KC_1-KC_Z
    s_cmp_lg_u32 s58, 0
    s_waitcnt vmcnt(12)
    s_barrier
    s_cbranch_scc1 L_gen
    buffer_load_dwordx4 v216, s[20:23], s90 offen offset:0 lds
    buffer_load_dwordx4 v217, s[20:23], s89 offen offset:1024 lds
    buffer_load_dwordx4 v218, s[20:23], s88 offen offset:2048 lds
    buffer_load_dwordx4 v219, s[20:23], 0 offen offset:3072 lds
    s_mov_b32 s45, 49152
    buffer_load_dwordx4 v[116:119], v2, s[24:27], s45 offen offset:0
    buffer_load_dwordx4 v[120:123], v2, s[24:27], s45 offen offset:512
    buffer_load_dwordx4 v[124:127], v2, s[24:27], s45 offen offset:1024
    buffer_load_dwordx4 v[128:131], v2, s[24:27], s45 offen offset:1536
    s_waitcnt vmcnt(12)
    s_barrier
    s_mov_b32 s45, 65536
    buffer_load_dwordx4 v[132:135], v2, s[24:27], s45 offen offset:0
    buffer_load_dwordx4 v[136:139], v2, s[24:27], s45 offen offset:512
    buffer_load_dwordx4 v[140:143], v2, s[24:27], s45 offen offset:1024
    buffer_load_dwordx4 v[144:147], v2, s[24:27], s45 offen offset:1536
    s_mov_b32 s45, 81920
    buffer_load_dwordx4 v[148:151], v2, s[24:27], s45 offen offset:0
    buffer_load_dwordx4 v[152:155], v2, s[24:27], s45 offen offset:512
    buffer_load_dwordx4 v[156:159], v2, s[24:27], s45 offen offset:1024
    buffer_load_dwordx4 v[160:163], v2, s[24:27], s45 offen offset:1536
    s_waitcnt vmcnt(12)
    s_barrier
    s_mov_b32 s45, 98304
    buffer_load_dwordx4 v[164:167], v2, s[24:27], s45 offen offset:0
    buffer_load_dwordx4 v[168:171], v2, s[24:27], s45 offen offset:512
    buffer_load_dwordx4 v[172:175], v2, s[24:27], s45 offen offset:1024
    buffer_load_dwordx4 v[176:179], v2, s[24:27], s45 offen offset:1536
    s_mov_b32 s45, 114688
    buffer_load_dwordx4 v[180:183], v2, s[24:27], s45 offen offset:0
    buffer_load_dwordx4 v[184:187], v2, s[24:27], s45 offen offset:512
    buffer_load_dwordx4 v[188:191], v2, s[24:27], s45 offen offset:1024
    buffer_load_dwordx4 v[192:195], v2, s[24:27], s45 offen offset:1536
    s_waitcnt vmcnt(16)
    s_mov_b64 vcc, s[96:97]
    v_cndmask_b32_dpp v196, v116, v118, vcc row_ror:8 row_mask:0xf bank_mask:0xf
    v_mov_b32_dpp v116, v118 row_ror:8 row_mask:0xf bank_mask:0xc
    v_cndmask_b32_dpp v197, v120, v122, vcc row_ror:8 row_mask:0xf bank_mask:0xf
    v_mov_b32_dpp v120, v122 row_ror:8 row_mask:0xf bank_mask:0xc
    v_cndmask_b32_dpp v198, v124, v126, vcc row_ror:8 row_mask:0xf bank_mask:0xf
    v_mov_b32_dpp v124, v126 row_ror:8 row_mask:0xf bank_mask:0xc
    v_cndmask_b32_dpp v199, v128, v130, vcc row_ror:8 row_mask:0xf bank_mask:0xf
    v_mov_b32_dpp v128, v130 row_ror:8 row_mask:0xf bank_mask:0xc
    v_cndmask_b32_dpp v200, v117, v119, vcc row_ror:8 row_mask:0xf bank_mask:0xf
    v_mov_b32_dpp v117, v119 row_ror:8 row_mask:0xf bank_mask:0xc
    v_cndmask_b32_dpp v201, v121, v123, vcc row_ror:8 row_mask:0xf bank_mask:0xf
    v_mov_b32_dpp v121, v123 row_ror:8 row_mask:0xf bank_mask:0xc
    v_cndmask_b32_dpp v202, v125, v127, vcc row_ror:8 row_mask:0xf bank_mask:0xf
    v_mov_b32_dpp v125, v127 row_ror:8 row_mask:0xf bank_mask:0xc
    v_cndmask_b32_dpp v203, v129, v131, vcc row_ror:8 row_mask:0xf bank_mask:0xf
    v_mov_b32_dpp v129, v131 row_ror:8 row_mask:0xf bank_mask:0xc
    v_perm_b32 v100, v120, v116, s94
    v_perm_b32 v101, v128, v124, s94
    v_perm_b32 v102, v197, v196, s94
    v_perm_b32 v103, v199, v198, s94
    v_perm_b32 v104, v120, v116, s95
    v_perm_b32 v105, v128, v124, s95
    v_perm_b32 v106, v197, v196, s95
    v_perm_b32 v107, v199, v198, s95
    v_perm_b32 v108, v121, v117, s94
    v_perm_b32 v109, v129, v125, s94
    v_perm_b32 v110, v201, v200, s94
    v_perm_b32 v111, v203, v202, s94
    v_perm_b32 v112, v121, v117, s95
    v_perm_b32 v113, v129, v125, s95
    v_perm_b32 v114, v201, v200, s95
    v_perm_b32 v115, v203, v202, s95
    s_waitcnt vmcnt(12)
    s_mov_b64 vcc, s[96:97]
    v_cndmask_b32_dpp v196, v132, v134, vcc row_ror:8 row_mask:0xf bank_mask:0xf
    v_mov_b32_dpp v132, v134 row_ror:8 row_mask:0xf bank_mask:0xc
    v_cndmask_b32_dpp v197, v136, v138, vcc row_ror:8 row_mask:0xf bank_mask:0xf
    v_mov_b32_dpp v136, v138 row_ror:8 row_mask:0xf bank_mask:0xc
    v_cndmask_b32_dpp v198, v140, v142, vcc row_ror:8 row_mask:0xf bank_mask:0xf
    v_mov_b32_dpp v140, v142 row_ror:8 row_mask:0xf bank_mask:0xc
    v_cndmask_b32_dpp v199, v144, v146, vcc row_ror:8 row_mask:0xf bank_mask:0xf
    v_mov_b32_dpp v144, v146 row_ror:8 row_mask:0xf bank_mask:0xc
    v_cndmask_b32_dpp v200, v133, v135, vcc row_ror:8 row_mask:0xf bank_mask:0xf
    v_mov_b32_dpp v133, v135 row_ror:8 row_mask:0xf bank_mask:0xc
    v_cndmask_b32_dpp v201, v137, v139, vcc row_ror:8 row_mask:0xf bank_mask:0xf
    v_mov_b32_dpp v137, v139 row_ror:8 row_mask:0xf bank_mask:0xc
    v_cndmask_b32_dpp v202, v141, v143, vcc row_ror:8 row_mask:0xf bank_mask:0xf
    v_mov_b32_dpp v141, v143 row_ror:8 row_mask:0xf bank_mask:0xc
    v_cndmask_b32_dpp v203, v145, v147, vcc row_ror:8 row_mask:0xf bank_mask:0xf
    v_mov_b32_dpp v145, v147 row_ror:8 row_mask:0xf bank_mask:0xc
    v_perm_b32 v116, v136, v132, s94
    v_perm_b32 v117, v144, v140, s94
    v_perm_b32 v118, v197, v196, s94
    v_perm_b32 v119, v199, v198, s94
    v_perm_b32 v120, v136, v132, s95
    v_perm_b32 v121, v144, v140, s95
    v_perm_b32 v122, v197, v196, s95
    v_perm_b32 v123, v199, v198, s95
    v_perm_b32 v124, v137, v133, s94
    v_perm_b32 v125, v145, v141, s94
    v_perm_b32 v126, v201, v200, s94
    v_perm_b32 v127, v203, v202, s94
    v_perm_b32 v128, v137, v133, s95
    v_perm_b32 v129, v145, v141, s95
    v_perm_b32 v130, v201, v200, s95
    v_perm_b32 v131, v203, v202, s95
    s_waitcnt vmcnt(8)
    s_mov_b64 vcc, s[96:97]
    v_cndmask_b32_dpp v196, v148, v150, vcc row_ror:8 row_mask:0xf bank_mask:0xf
    v_mov_b32_dpp v148, v150 row_ror:8 row_mask:0xf bank_mask:0xc
    v_cndmask_b32_dpp v197, v152, v154, vcc row_ror:8 row_mask:0xf bank_mask:0xf
    v_mov_b32_dpp v152, v154 row_ror:8 row_mask:0xf bank_mask:0xc
    v_cndmask_b32_dpp v198, v156, v158, vcc row_ror:8 row_mask:0xf bank_mask:0xf
    v_mov_b32_dpp v156, v158 row_ror:8 row_mask:0xf bank_mask:0xc
    v_cndmask_b32_dpp v199, v160, v162, vcc row_ror:8 row_mask:0xf bank_mask:0xf
    v_mov_b32_dpp v160, v162 row_ror:8 row_mask:0xf bank_mask:0xc
    v_cndmask_b32_dpp v200, v149, v151, vcc row_ror:8 row_mask:0xf bank_mask:0xf
    v_mov_b32_dpp v149, v151 row_ror:8 row_mask:0xf bank_mask:0xc
    v_cndmask_b32_dpp v201, v153, v155, vcc row_ror:8 row_mask:0xf bank_mask:0xf
    v_mov_b32_dpp v153, v155 row_ror:8 row_mask:0xf bank_mask:0xc
    v_cndmask_b32_dpp v202, v157, v159, vcc row_ror:8 row_mask:0xf bank_mask:0xf
    v_mov_b32_dpp v157, v159 row_ror:8 row_mask:0xf bank_mask:0xc
    v_cndmask_b32_dpp v203, v161, v163, vcc row_ror:8 row_mask:0xf bank_mask:0xf
    v_mov_b32_dpp v161, v163 row_ror:8 row_mask:0xf bank_mask:0xc
    v_perm_b32 v132, v152, v148, s94
    v_perm_b32 v133, v160, v156, s94
    v_perm_b32 v134, v197, v196, s94
    v_perm_b32 v135, v199, v198, s94
    v_perm_b32 v136, v152, v148, s95
    v_perm_b32 v137, v160, v156, s95
    v_perm_b32 v138, v197, v196, s95
    v_perm_b32 v139, v199, v198, s95
    v_perm_b32 v140, v153, v149, s94
    v_perm_b32 v141, v161, v157, s94
    v_perm_b32 v142, v201, v200, s94
    v_perm_b32 v143, v203, v202, s94
    v_perm_b32 v144, v153, v149, s95
    v_perm_b32 v145, v161, v157, s95
    v_perm_b32 v146, v201, v200, s95
    v_perm_b32 v147, v203, v202, s95
    s_mov_b64 vcc, s[96:97]
    s_cmp_lt_u32 s39, 640000
    s_waitcnt lgkmcnt(0)
    s_barrier
    s_cbranch_scc1 L_slow
    ds_read_b128 v[20:23], v10 offset:0
    ds_read_b128 v[24:27], v11 offset:0
    ds_read_b128 v[28:31], v12 offset:0
    ds_read_b128 v[32:35], v13 offset:0
    ds_read_b128 v[36:39], v10 offset:256
    ds_read_b128 v[40:43], v11 offset:256
    ds_read_b128 v[44:47], v12 offset:256
    ds_read_b128 v[48:51], v13 offset:256
    s_waitcnt lgkmcnt(7)
    v_mfma_f32_16x16x32_bf16 v[204:207], v[20:23], v[52:55], 0
    v_mfma_f32_16x16x32_bf16 v[208:211], v[20:23], v[56:59], 0
    v_mfma_f32_16x16x32_bf16 v[212:215], v[20:23], v[60:63], 0
    v_mfma_f32_16x16x32_bf16 v[216:219], v[20:23], v[64:67], 0
    ds_read_b128 v[20:23], v10 offset:8192
    s_waitcnt lgkmcnt(7)
    v_mfma_f32_16x16x32_bf16 v[204:207], v[24:27], v[68:71], v[204:207]
    s_waitcnt vmcnt(4)
    v_cndmask_b32_dpp v196, v164, v166, vcc row_ror:8 row_mask:0xf bank_mask:0xf
    v_mov_b32_dpp v164, v166 row_ror:8 row_mask:0xf bank_mask:0xc
    v_mfma_f32_16x16x32_bf16 v[208:211], v[24:27], v[72:75], v[208:211]
    v_cndmask_b32_dpp v197, v168, v170, vcc row_ror:8 row_mask:0xf bank_mask:0xf
    v_mov_b32_dpp v168, v170 row_ror:8 row_mask:0xf bank_mask:0xc
    v_cndmask_b32_dpp v198, v172, v174, vcc row_ror:8 row_mask:0xf bank_mask:0xf
    v_mfma_f32_16x16x32_bf16 v[212:215], v[24:27], v[76:79], v[212:215]
    v_mov_b32_dpp v172, v174 row_ror:8 row_mask:0xf bank_mask:0xc
    v_cndmask_b32_dpp v199, v176, v178, vcc row_ror:8 row_mask:0xf bank_mask:0xf
    v_mov_b32_dpp v176, v178 row_ror:8 row_mask:0xf bank_mask:0xc
    v_mfma_f32_16x16x32_bf16 v[216:219], v[24:27], v[80:83], v[216:219]
    v_cndmask_b32_dpp v200, v165, v167, vcc row_ror:8 row_mask:0xf bank_mask:0xf
    v_mov_b32_dpp v165, v167 row_ror:8 row_mask:0xf bank_mask:0xc
    v_cndmask_b32_dpp v201, v169, v171, vcc row_ror:8 row_mask:0xf bank_mask:0xf
    ds_read_b128 v[24:27], v11 offset:8192
    s_waitcnt lgkmcnt(7)
    v_mfma_f32_16x16x32_bf16 v[204:207], v[28:31], v[84:87], v[204:207]
    v_mov_b32_dpp v169, v171 row_ror:8 row_mask:0xf bank_mask:0xc
    v_cndmask_b32_dpp v202, v173, v175, vcc row_ror:8 row_mask:0xf bank_mask:0xf
    v_mov_b32_dpp v173, v175 row_ror:8 row_mask:0xf bank_mask:0xc
    v_mfma_f32_16x16x32_bf16 v[208:211], v[28:31], v[88:91], v[208:211]
    v_cndmask_b32_dpp v203, v177, v179, vcc row_ror:8 row_mask:0xf bank_mask:0xf
    v_mov_b32_dpp v177, v179 row_ror:8 row_mask:0xf bank_mask:0xc
    v_perm_b32 v148, v168, v164, s94
    v_mfma_f32_16x16x32_bf16 v[212:215], v[28:31], v[92:95], v[212:215]
    v_perm_b32 v149, v176, v172, s94
    v_perm_b32 v150, v197, v196, s94
    v_perm_b32 v151, v199, v198, s94
    v_mfma_f32_16x16x32_bf16 v[216:219], v[28:31], v[96:99], v[216:219]
    v_perm_b32 v152, v168, v164, s95
    v_perm_b32 v153, v176, v172, s95
    v_perm_b32 v154, v197, v196, s95
    ds_read_b128 v[28:31], v12 offset:8192
    s_waitcnt lgkmcnt(7)
    v_mfma_f32_16x16x32_bf16 v[204:207], v[32:35], v[100:103], v[204:207]
    v_perm_b32 v155, v199, v198, s95
    v_perm_b32 v156, v169, v165, s94
    v_perm_b32 v157, v177, v173, s94
    v_mfma_f32_16x16x32_bf16 v[208:211], v[32:35], v[104:107], v[208:211]
    v_perm_b32 v158, v201, v200, s94
    v_perm_b32 v159, v203, v202, s94
    v_perm_b32 v160, v169, v165, s95
    v_mfma_f32_16x16x32_bf16 v[212:215], v[32:35], v[108:111], v[212:215]
    v_perm_b32 v161, v177, v173, s95
    v_perm_b32 v162, v201, v200, s95
    v_perm_b32 v163, v203, v202, s95
    v_mfma_f32_16x16x32_bf16 v[216:219], v[32:35], v[112:115], v[216:219]
    ds_read_b128 v[32:35], v13 offset:8192
    s_waitcnt lgkmcnt(7)
    v_mfma_f32_16x16x32_bf16 v[204:207], v[36:39], v[116:119], v[204:207]
    s_waitcnt vmcnt(0)
    v_cndmask_b32_dpp v196, v180, v182, vcc row_ror:8 row_mask:0xf bank_mask:0xf
    v_mov_b32_dpp v180, v182 row_ror:8 row_mask:0xf bank_mask:0xc
    v_mfma_f32_16x16x32_bf16 v[208:211], v[36:39], v[120:123], v[208:211]
    v_cndmask_b32_dpp v197, v184, v186, vcc row_ror:8 row_mask:0xf bank_mask:0xf
    v_mov_b32_dpp v184, v186 row_ror:8 row_mask:0xf bank_mask:0xc
    v_cndmask_b32_dpp v198, v188, v190, vcc row_ror:8 row_mask:0xf bank_mask:0xf
    v_mfma_f32_16x16x32_bf16 v[212:215], v[36:39], v[124:127], v[212:215]
    v_mov_b32_dpp v188, v190 row_ror:8 row_mask:0xf bank_mask:0xc
    v_cndmask_b32_dpp v199, v192, v194, vcc row_ror:8 row_mask:0xf bank_mask:0xf
    v_mov_b32_dpp v192, v194 row_ror:8 row_mask:0xf bank_mask:0xc
    v_mfma_f32_16x16x32_bf16 v[216:219], v[36:39], v[128:131], v[216:219]
    v_cndmask_b32_dpp v200, v181, v183, vcc row_ror:8 row_mask:0xf bank_mask:0xf
    v_mov_b32_dpp v181, v183 row_ror:8 row_mask:0xf bank_mask:0xc
    v_cndmask_b32_dpp v201, v185, v187, vcc row_ror:8 row_mask:0xf bank_mask:0xf
    ds_read_b128 v[36:39], v10 offset:8448
    s_waitcnt lgkmcnt(7)
    v_mfma_f32_16x16x32_bf16 v[204:207], v[40:43], v[132:135], v[204:207]
    v_mov_b32_dpp v185, v187 row_ror:8 row_mask:0xf bank_mask:0xc
    v_cndmask_b32_dpp v202, v189, v191, vcc row_ror:8 row_mask:0xf bank_mask:0xf
    v_mov_b32_dpp v189, v191 row_ror:8 row_mask:0xf bank_mask:0xc
    v_mfma_f32_16x16x32_bf16 v[208:211], v[40:43], v[136:139], v[208:211]
    v_cndmask_b32_dpp v203, v193, v195, vcc row_ror:8 row_mask:0xf bank_mask:0xf
    v_mov_b32_dpp v193, v195 row_ror:8 row_mask:0xf bank_mask:0xc
    v_perm_b32 v164, v184, v180, s94
    v_mfma_f32_16x16x32_bf16 v[212:215], v[40:43], v[140:143], v[212:215]
    v_perm_b32 v165, v192, v188, s94
    v_perm_b32 v166, v197, v196, s94
    v_perm_b32 v167, v199, v198, s94
    v_mfma_f32_16x16x32_bf16 v[216:219], v[40:43], v[144:147], v[216:219]
    v_perm_b32 v168, v184, v180, s95
    v_perm_b32 v169, v192, v188, s95
    v_perm_b32 v170, v197, v196, s95
    ds_read_b128 v[40:43], v11 offset:8448
    s_waitcnt lgkmcnt(7)
    v_mfma_f32_16x16x32_bf16 v[204:207], v[44:47], v[148:151], v[204:207]
    v_perm_b32 v171, v199, v198, s95
    v_perm_b32 v172, v185, v181, s94
    v_perm_b32 v173, v193, v189, s94
    v_mfma_f32_16x16x32_bf16 v[208:211], v[44:47], v[152:155], v[208:211]
    v_perm_b32 v174, v201, v200, s94
    v_perm_b32 v175, v203, v202, s94
    v_perm_b32 v176, v185, v181, s95
    v_mfma_f32_16x16x32_bf16 v[212:215], v[44:47], v[156:159], v[212:215]
    v_perm_b32 v177, v193, v189, s95
    v_perm_b32 v178, v201, v200, s95
    v_perm_b32 v179, v203, v202, s95
    v_mfma_f32_16x16x32_bf16 v[216:219], v[44:47], v[160:163], v[216:219]
    ds_read_b128 v[44:47], v12 offset:8448
    s_waitcnt lgkmcnt(7)
    v_mfma_f32_16x16x32_bf16 v[204:207], v[48:51], v[164:167], v[204:207]
    v_mfma_f32_16x16x32_bf16 v[208:211], v[48:51], v[168:171], v[208:211]
    v_mfma_f32_16x16x32_bf16 v[212:215], v[48:51], v[172:175], v[212:215]
    v_mfma_f32_16x16x32_bf16 v[216:219], v[48:51], v[176:179], v[216:219]
    ds_read_b128 v[48:51], v13 offset:8448
    s_waitcnt lgkmcnt(7)
    v_mfma_f32_16x16x32_bf16 v[220:223], v[20:23], v[52:55], 0
    v_mfma_f32_16x16x32_bf16 v[224:227], v[20:23], v[56:59], 0
    v_mfma_f32_16x16x32_bf16 v[228:231], v[20:23], v[60:63], 0
    v_mfma_f32_16x16x32_bf16 v[232:235], v[20:23], v[64:67], 0
    ds_read_b128 v[20:23], v10 offset:16384
    s_waitcnt lgkmcnt(7)
    v_mfma_f32_16x16x32_bf16 v[220:223], v[24:27], v[68:71], v[220:223]
    v_mfma_f32_16x16x32_bf16 v[224:227], v[24:27], v[72:75], v[224:227]
    v_mfma_f32_16x16x32_bf16 v[228:231], v[24:27], v[76:79], v[228:231]
    v_mfma_f32_16x16x32_bf16 v[232:235], v[24:27], v[80:83], v[232:235]
    ds_read_b128 v[24:27], v11 offset:16384
    s_waitcnt lgkmcnt(7)
    v_mfma_f32_16x16x32_bf16 v[220:223], v[28:31], v[84:87], v[220:223]
    v_cvt_pk_bf16_f32 v236, v204, v208
    v_mfma_f32_16x16x32_bf16 v[224:227], v[28:31], v[88:91], v[224:227]
    v_cvt_pk_bf16_f32 v237, v212, v216
    v_mfma_f32_16x16x32_bf16 v[228:231], v[28:31], v[92:95], v[228:231]
    v_cvt_pk_bf16_f32 v244, v205, v209
    v_mfma_f32_16x16x32_bf16 v[232:235], v[28:31], v[96:99], v[232:235]
    v_cvt_pk_bf16_f32 v245, v213, v217
    ds_read_b128 v[28:31], v12 offset:16384
    s_waitcnt lgkmcnt(7)
    v_mfma_f32_16x16x32_bf16 v[220:223], v[32:35], v[100:103], v[220:223]
    v_cvt_pk_bf16_f32 v240, v206, v210
    v_mfma_f32_16x16x32_bf16 v[224:227], v[32:35], v[104:107], v[224:227]
    v_cvt_pk_bf16_f32 v241, v214, v218
    v_mfma_f32_16x16x32_bf16 v[228:231], v[32:35], v[108:111], v[228:231]
    v_cvt_pk_bf16_f32 v246, v207, v211
    v_mfma_f32_16x16x32_bf16 v[232:235], v[32:35], v[112:115], v[232:235]
    v_cvt_pk_bf16_f32 v247, v215, v219
    ds_read_b128 v[32:35], v13 offset:16384
    s_waitcnt lgkmcnt(7)
    v_mfma_f32_16x16x32_bf16 v[220:223], v[36:39], v[116:119], v[220:223]
    v_cndmask_b32_dpp v238, v236, v244, vcc row_ror:8 row_mask:0xf bank_mask:0xf
    v_mfma_f32_16x16x32_bf16 v[224:227], v[36:39], v[120:123], v[224:227]
    v_cndmask_b32_dpp v239, v237, v245, vcc row_ror:8 row_mask:0xf bank_mask:0xf
    v_mfma_f32_16x16x32_bf16 v[228:231], v[36:39], v[124:127], v[228:231]
    v_mov_b32_dpp v236, v244 row_ror:8 row_mask:0xf bank_mask:0xc
    v_mfma_f32_16x16x32_bf16 v[232:235], v[36:39], v[128:131], v[232:235]
    v_mov_b32_dpp v237, v245 row_ror:8 row_mask:0xf bank_mask:0xc
    ds_read_b128 v[36:39], v10 offset:16640
    s_waitcnt lgkmcnt(7)
    v_mfma_f32_16x16x32_bf16 v[220:223], v[40:43], v[132:135], v[220:223]
    buffer_store_dwordx4 v[236:239], v14, s[32:35], 0 offen nt sc1
    v_mfma_f32_16x16x32_bf16 v[224:227], v[40:43], v[136:139], v[224:227]
    v_cndmask_b32_dpp v242, v240, v246, vcc row_ror:8 row_mask:0xf bank_mask:0xf
    v_mfma_f32_16x16x32_bf16 v[228:231], v[40:43], v[140:143], v[228:231]
    v_cndmask_b32_dpp v243, v241, v247, vcc row_ror:8 row_mask:0xf bank_mask:0xf
    v_mfma_f32_16x16x32_bf16 v[232:235], v[40:43], v[144:147], v[232:235]
    v_mov_b32_dpp v240, v246 row_ror:8 row_mask:0xf bank_mask:0xc
    ds_read_b128 v[40:43], v11 offset:16640
    s_waitcnt lgkmcnt(7)
    v_mfma_f32_16x16x32_bf16 v[220:223], v[44:47], v[148:151], v[220:223]
    v_mov_b32_dpp v241, v247 row_ror:8 row_mask:0xf bank_mask:0xc
    v_mfma_f32_16x16x32_bf16 v[224:227], v[44:47], v[152:155], v[224:227]
    buffer_store_dwordx4 v[240:243], v15, s[32:35], 0 offen nt sc1
    v_mfma_f32_16x16x32_bf16 v[228:231], v[44:47], v[156:159], v[228:231]
    v_mfma_f32_16x16x32_bf16 v[232:235], v[44:47], v[160:163], v[232:235]
    ds_read_b128 v[44:47], v12 offset:16640
    s_waitcnt lgkmcnt(7)
    v_mfma_f32_16x16x32_bf16 v[220:223], v[48:51], v[164:167], v[220:223]
    v_mfma_f32_16x16x32_bf16 v[224:227], v[48:51], v[168:171], v[224:227]
    v_mfma_f32_16x16x32_bf16 v[228:231], v[48:51], v[172:175], v[228:231]
    v_mfma_f32_16x16x32_bf16 v[232:235], v[48:51], v[176:179], v[232:235]
    ds_read_b128 v[48:51], v13 offset:16640
    s_waitcnt lgkmcnt(7)
    v_mfma_f32_16x16x32_bf16 v[204:207], v[20:23], v[52:55], 0
    v_mfma_f32_16x16x32_bf16 v[208:211], v[20:23], v[56:59], 0
    v_mfma_f32_16x16x32_bf16 v[212:215], v[20:23], v[60:63], 0
    v_mfma_f32_16x16x32_bf16 v[216:219], v[20:23], v[64:67], 0
    s_waitcnt lgkmcnt(6)
    v_mfma_f32_16x16x32_bf16 v[204:207], v[24:27], v[68:71], v[204:207]
    v_mfma_f32_16x16x32_bf16 v[208:211], v[24:27], v[72:75], v[208:211]
    v_mfma_f32_16x16x32_bf16 v[212:215], v[24:27], v[76:79], v[212:215]
    v_mfma_f32_16x16x32_bf16 v[216:219], v[24:27], v[80:83], v[216:219]
    s_waitcnt lgkmcnt(5)
    v_mfma_f32_16x16x32_bf16 v[204:207], v[28:31], v[84:87], v[204:207]
    v_cvt_pk_bf16_f32 v236, v220, v224
    v_mfma_f32_16x16x32_bf16 v[208:211], v[28:31], v[88:91], v[208:211]
    v_cvt_pk_bf16_f32 v237, v228, v232
    v_mfma_f32_16x16x32_bf16 v[212:215], v[28:31], v[92:95], v[212:215]
    v_cvt_pk_bf16_f32 v244, v221, v225
    v_mfma_f32_16x16x32_bf16 v[216:219], v[28:31], v[96:99], v[216:219]
    v_cvt_pk_bf16_f32 v245, v229, v233
    s_waitcnt lgkmcnt(4)
    v_mfma_f32_16x16x32_bf16 v[204:207], v[32:35], v[100:103], v[204:207]
    v_cvt_pk_bf16_f32 v240, v222, v226
    v_mfma_f32_16x16x32_bf16 v[208:211], v[32:35], v[104:107], v[208:211]
    v_cvt_pk_bf16_f32 v241, v230, v234
    v_mfma_f32_16x16x32_bf16 v[212:215], v[32:35], v[108:111], v[212:215]
    v_cvt_pk_bf16_f32 v246, v223, v227
    v_mfma_f32_16x16x32_bf16 v[216:219], v[32:35], v[112:115], v[216:219]
    v_cvt_pk_bf16_f32 v247, v231, v235
    s_waitcnt lgkmcnt(3)
    v_mfma_f32_16x16x32_bf16 v[204:207], v[36:39], v[116:119], v[204:207]
    v_cndmask_b32_dpp v238, v236, v244, vcc row_ror:8 row_mask:0xf bank_mask:0xf
    v_mfma_f32_16x16x32_bf16 v[208:211], v[36:39], v[120:123], v[208:211]
    v_cndmask_b32_dpp v239, v237, v245, vcc row_ror:8 row_mask:0xf bank_mask:0xf
    v_mfma_f32_16x16x32_bf16 v[212:215], v[36:39], v[124:127], v[212:215]
    v_mov_b32_dpp v236, v244 row_ror:8 row_mask:0xf bank_mask:0xc
    v_mfma_f32_16x16x32_bf16 v[216:219], v[36:39], v[128:131], v[216:219]
    v_mov_b32_dpp v237, v245 row_ror:8 row_mask:0xf bank_mask:0xc
    s_waitcnt lgkmcnt(2)
    v_mfma_f32_16x16x32_bf16 v[204:207], v[40:43], v[132:135], v[204:207]
    buffer_store_dwordx4 v[236:239], v16, s[32:35], 0 offen nt sc1
    v_mfma_f32_16x16x32_bf16 v[208:211], v[40:43], v[136:139], v[208:211]
    v_cndmask_b32_dpp v242, v240, v246, vcc row_ror:8 row_mask:0xf bank_mask:0xf
    v_mfma_f32_16x16x32_bf16 v[212:215], v[40:43], v[140:143], v[212:215]
    v_cndmask_b32_dpp v243, v241, v247, vcc row_ror:8 row_mask:0xf bank_mask:0xf
    v_mfma_f32_16x16x32_bf16 v[216:219], v[40:43], v[144:147], v[216:219]
    v_mov_b32_dpp v240, v246 row_ror:8 row_mask:0xf bank_mask:0xc
    s_waitcnt lgkmcnt(1)
    v_mfma_f32_16x16x32_bf16 v[204:207], v[44:47], v[148:151], v[204:207]
    v_mov_b32_dpp v241, v247 row_ror:8 row_mask:0xf bank_mask:0xc
    v_mfma_f32_16x16x32_bf16 v[208:211], v[44:47], v[152:155], v[208:211]
    buffer_store_dwordx4 v[240:243], v17, s[32:35], 0 offen nt sc1
    v_mfma_f32_16x16x32_bf16 v[212:215], v[44:47], v[156:159], v[212:215]
    v_mfma_f32_16x16x32_bf16 v[216:219], v[44:47], v[160:163], v[216:219]
    s_waitcnt lgkmcnt(0)
    v_mfma_f32_16x16x32_bf16 v[204:207], v[48:51], v[164:167], v[204:207]
    v_mfma_f32_16x16x32_bf16 v[208:211], v[48:51], v[168:171], v[208:211]
    v_mfma_f32_16x16x32_bf16 v[212:215], v[48:51], v[172:175], v[212:215]
    v_mfma_f32_16x16x32_bf16 v[216:219], v[48:51], v[176:179], v[216:219]
    s_nop 6
    s_mov_b32 exec_hi, 0
    v_cvt_pk_bf16_f32 v236, v204, v208
    v_cvt_pk_bf16_f32 v237, v212, v216
    v_cvt_pk_bf16_f32 v244, v205, v209
    v_cvt_pk_bf16_f32 v245, v213, v217
    v_cvt_pk_bf16_f32 v240, v206, v210
    v_cvt_pk_bf16_f32 v241, v214, v218
    v_cvt_pk_bf16_f32 v246, v207, v211
    v_cvt_pk_bf16_f32 v247, v215, v219
    v_cndmask_b32_dpp v238, v236, v244, vcc row_ror:8 row_mask:0xf bank_mask:0xf
    v_cndmask_b32_dpp v239, v237, v245, vcc row_ror:8 row_mask:0xf bank_mask:0xf
    v_mov_b32_dpp v236, v244 row_ror:8 row_mask:0xf bank_mask:0xc
    v_mov_b32_dpp v237, v245 row_ror:8 row_mask:0xf bank_mask:0xc
    buffer_store_dwordx4 v[236:239], v18, s[32:35], 0 offen nt sc1
    v_cndmask_b32_dpp v242, v240, v246, vcc row_ror:8 row_mask:0xf bank_mask:0xf
    v_cndmask_b32_dpp v243, v241, v247, vcc row_ror:8 row_mask:0xf bank_mask:0xf
    v_mov_b32_dpp v240, v246 row_ror:8 row_mask:0xf bank_mask:0xc
    v_mov_b32_dpp v241, v247 row_ror:8 row_mask:0xf bank_mask:0xc
    buffer_store_dwordx4 v[240:243], v19, s[32:35], 0 offen nt sc1
    s_endpgm
    .p2align 6
    s_nop 0
C_head:
    v_lshrrev_b32 v237, 3, v1
    v_bitop3_b32 v238, v237, 6, v1 bitop3:0x6a
    v_and_b32 v238, 7, v238
    s_lshl_b32 s3, s93, 7
    v_lshl_add_u32 v238, v238, 4, s3
    v_and_b32 v236, 4, v237
    v_add_u32 v237, v236, v237
    v_lshl_add_u32 v236, v237, 9, v238
    s_mov_b32 s26, 134144
    s_mov_b32 s27, 0x20000
    s_waitcnt lgkmcnt(0)
    s_sub_u32 s24, s10, 3072
    s_subb_u32 s25, s11, 0
    s_add_u32 m0, s54, 0
    s_movk_i32 s99, 3072
    buffer_load_dwordx4 v236, s[24:27], s99 offen offset:0 lds
    s_mov_b32 s99, 10240
    buffer_load_dwordx4 v236, s[24:27], s99 offen offset:1024 lds
    s_cmp_lt_u32 s2, 125
    s_cbranch_scc1 C_start
    s_add_u32 m0, s54, 0
    s_mov_b32 s99, 3072
    buffer_load_dwordx4 v236, s[24:27], s99 offen offset:2048 lds
    s_mov_b32 s99, 10240
    buffer_load_dwordx4 v236, s[24:27], s99 offen offset:3072 lds
    s_add_u32 m0, s54, 4096
    s_mov_b32 s99, 19456
    buffer_load_dwordx4 v236, s[24:27], s99 offen offset:0 lds
    s_mov_b32 s99, 26624
    buffer_load_dwordx4 v236, s[24:27], s99 offen offset:1024 lds
    s_mov_b32 s99, 19456
    buffer_load_dwordx4 v236, s[24:27], s99 offen offset:2048 lds
    s_mov_b32 s99, 26624
    buffer_load_dwordx4 v236, s[24:27], s99 offen offset:3072 lds
C_start:
    s_and_b32 s3, s2, 7
    s_bfe_u32 s56, s2, 0x40003
    s_lshl4_add_u32 s3, s3, s56
    s_lshr_b32 s56, s2, 7
    s_lshl1_add_u32 s56, s3, s56
    s_mov_b32 s22, 5123072
    s_mov_b32 s23, 0x20000
    s_mov_b32 s39, 640000
    s_mov_b32 s63, KC_0-KC_Z
    s_sub_u32 s20, s4, 3072
    s_subb_u32 s21, s5, 0
    v_lshrrev_b32 v241, 5, v1
    v_and_b32 v242, 31, v1
    s_mul_i32 s3, s93, 10
    v_add_u32 v237, s3, v241
    s_lshl_b32 s47, s3, 9
    s_lshl_b32 s3, s93, 8
    s_add_u32 s3, s3, s56
    s_lshl_b32 s3, s3, KC_9-KC_Z
    v_lshl_add_u32 v238, v241, 19, s3
    v_add_lshl_u32 v239, v237, 0, 1
    v_bitop3_b32 v239, v239, 14, v242 bitop3:0x6a
    v_lshl_add_u32 v244, v239, 4, v238
    s_add_u32 m0, s47, 133120
    s_mov_b32 s99, 3072
    buffer_load_dwordx4 v244, s[20:23], s99 offen offset:0 lds
    v_add_lshl_u32 v239, v237, 2, 1
    v_bitop3_b32 v239, v239, 14, v242 bitop3:0x6a
    v_lshl_add_u32 v245, v239, 4, v238
    s_mov_b32 s99, 1050624
    buffer_load_dwordx4 v245, s[20:23], s99 offen offset:1024 lds
    v_add_lshl_u32 v239, v237, 4, 1
    v_bitop3_b32 v239, v239, 14, v242 bitop3:0x6a
    v_lshl_add_u32 v246, v239, 4, v238
    s_mov_b32 s99, 2098176
    buffer_load_dwordx4 v246, s[20:23], s99 offen offset:2048 lds
    v_add_lshl_u32 v239, v237, 6, 1
    v_bitop3_b32 v239, v239, 14, v242 bitop3:0x6a
    v_lshl_add_u32 v247, v239, 4, v238
    s_mov_b32 s99, 3145728
    buffer_load_dwordx4 v247, s[20:23], s99 offen offset:3072 lds
    s_add_u32 m0, s47, 137216
    s_mov_b32 s99, 4197376
    buffer_load_dwordx4 v244, s[20:23], s99 offen offset:0 lds
    s_cmp_ge_u32 s2, 125
    s_cbranch_scc1 C_noi
    s_barrier
C_noi:
    s_add_u32 s60, s18, 4194304
    s_addc_u32 s61, s19, 0
    s_load_dwordx2 s[52:53], s[60:61], 0
    v_mul_u32_u24 v254, 2016, v1
    v_add_u32 v254, 155588, v254
    v_mov_b32 v228, 8388351
    v_mov_b32 v229, v228
    v_mov_b32 v230, v228
    v_mov_b32 v231, v228
    s_mov_b32 s3, 151552
    v_lshl_add_u32 v237, v0, 4, s3
    ds_write_b128 v237, v[228:231]
    ds_write_b128 v237, v[228:231] offset:4096
    v_cmp_gt_u32 vcc, 4, v1
    v_add_u32 v237, 60, v254
    v_lshlrev_b32 v251, 2, v1
    v_cndmask_b32 v237, 0, v237, vcc
    s_mov_b64 exec, 0xff
    ds_write_b32 v251, v237
    s_mov_b64 exec, -1
    s_cmp_ge_u32 s2, 125
    s_cbranch_scc1 C_noii
    s_barrier
    s_barrier
    s_add_u32 m0, s54, 0
    s_movk_i32 s99, 3072
    buffer_load_dwordx4 v236, s[24:27], s99 offen offset:2048 lds
    s_mov_b32 s99, 10240
    buffer_load_dwordx4 v236, s[24:27], s99 offen offset:3072 lds
    s_add_u32 m0, s54, 4096
    s_mov_b32 s99, 19456
    buffer_load_dwordx4 v236, s[24:27], s99 offen offset:0 lds
    s_mov_b32 s99, 26624
    buffer_load_dwordx4 v236, s[24:27], s99 offen offset:1024 lds
    s_mov_b32 s99, 19456
    buffer_load_dwordx4 v236, s[24:27], s99 offen offset:2048 lds
    s_mov_b32 s99, 26624
    buffer_load_dwordx4 v236, s[24:27], s99 offen offset:3072 lds
C_noii:
    s_add_u32 m0, s54, 8192
    s_mov_b32 s99, 35840
    buffer_load_dwordx4 v236, s[24:27], s99 offen offset:0 lds
    v_lshrrev_b32_e64 v237, 2, v1
    v_lshl_add_u32 v237, v237, 7, s54
    v_bfe_u32 v238, v1, 3, 2
    v_lshl_add_u32 v237, v238, 5, v237
    v_and_b32_e64 v238, 3, v1
    v_lshl_add_u32 v24, v238, 3, v237
    v_xor_b32 v25, 32, v24
    v_xor_b32 v26, 64, v24
    v_xor_b32 v27, 0x60, v24
    v_and_b32_e64 v239, 15, v1
    s_mov_b32 s99, 43008
    buffer_load_dwordx4 v236, s[24:27], s99 offen offset:1024 lds
    v_lshrrev_b32 v240, 4, v1
    v_and_b32 v238, 7, v1
    v_lshlrev_b32 v238, 1, v238
    v_xor_b32 v238, v238, v240
    v_lshlrev_b32_e64 v238, 4, v238
    v_lshl_add_u32 v20, v239, 9, v238
    v_add_u32 v20, 133120, v20
    v_xor_b32_e64 v21, 64, v20
    v_xor_b32 v22, 0x80, v20
    v_xor_b32 v23, 0xc0, v20
    s_mov_b32 s99, 35840
    buffer_load_dwordx4 v236, s[24:27], s99 offen offset:2048 lds
    v_and_b32_e64 v237, 7, v1
    v_lshl_add_u32 v238, v237, 10, v238
    v_bfe_u32 v237, v1, 3, 1
    v_lshl_add_u32 v238, v237, 9, v238
    v_add_u32_e64 v2, s54, v238
    v_bfe_u32 v237, v1, 2, 3
    v_mul_u32_u24 v237, 0x420, v237
    v_lshl_add_u32 v237, v241, 9, v237
    v_and_b32_e64 v238, 3, v1
    v_lshl_add_u32 v237, v238, 3, v237
    s_mov_b32 s99, 43008
    buffer_load_dwordx4 v236, s[24:27], s99 offen offset:3072 lds
    v_add_u32 v6, s54, v237
    s_lshl_b32 s3, s93, 2
    v_lshl_add_u32 v14, v239, 4, s3
    s_mul_i32 s3, s93, 10
    v_add_u32 v237, s3, v239
    v_and_b32 v238, 7, v237
    v_lshlrev_b32 v238, 1, v238
    v_xor_b32 v238, v238, v240
    v_lshlrev_b32 v238, 4, v238
    v_lshl_add_u32 v237, v237, 9, v238
    s_add_u32 m0, s54, 12288
    s_mov_b32 s99, 52224
    buffer_load_dwordx4 v236, s[24:27], s99 offen offset:0 lds
    v_add_u32 v237, 133120, v237
    v_add_u32 v238, 6, v239
    v_lshrrev_b32 v238, 4, v238
    v_lshl_or_b32 v16, v238, 31, v237
    v_lshrrev_b32 v237, 1, v240
    v_xor_b32 v237, v237, v240
    v_and_b32 v237, 1, v237
    v_mul_u32_u24 v237, 48, v237
    s_lshl_b32 s3, s93, 7
    v_xor_b32 v237, s3, v237
    s_mov_b32 s99, 59392
    buffer_load_dwordx4 v236, s[24:27], s99 offen offset:1024 lds
    v_xor_b32 v249, v237, v20
    v_xor_b32 v250, 64, v249
    s_mov_b32 s57, 0xbdb8aa3b
    s_mov_b32 s88, 0xbdb8aa3b
    s_mov_b32 s89, 0xbdb8aa3b
    v_xor_b32 v3, 64, v2
    v_xor_b32 v17, 64, v16
    v_xor_b32 v4, 128, v2
    v_xor_b32 v18, 128, v16
    v_xor_b32 v5, 192, v2
    s_mov_b32 s99, 52224
    buffer_load_dwordx4 v236, s[24:27], s99 offen offset:2048 lds
    v_xor_b32 v19, 192, v16
    v_xor_b32 v7, 32, v6
    v_xor_b32 v8, 64, v6
    v_xor_b32 v9, 96, v6
    v_xor_b32 v10, 128, v6
    v_xor_b32 v11, 160, v6
    v_xor_b32 v12, 192, v6
    v_xor_b32 v13, 224, v6
    s_mov_b32 s99, 59392
    buffer_load_dwordx4 v236, s[24:27], s99 offen offset:3072 lds
    s_cmp_lt_u32 s2, 125
    s_waitcnt vmcnt(14) lgkmcnt(0)
    s_cbranch_scc1 C_tile
    s_waitcnt vmcnt(8)
C_tile:
    s_barrier
    ds_read_b128 v[60:63], v20 offset:0
    ds_read_b128 v[92:95], v20 offset:8192
    ds_read_b128 v[124:127], v20 offset:16384
    ds_read_b128 v[64:67], v21 offset:0
    ds_read_b128 v[96:99], v21 offset:8192
    ds_read_b128 v[128:131], v21 offset:16384
    s_waitcnt vmcnt(8)
    ds_read_b64_tr_b16 v[156:157], v24 offset:0
    ds_read_b64_tr_b16 v[158:159], v24 offset:2048
    ds_read_b64_tr_b16 v[160:161], v25 offset:0
    ds_read_b64_tr_b16 v[162:163], v25 offset:2048
    ds_read_b64_tr_b16 v[164:165], v26 offset:0
    ds_read_b64_tr_b16 v[166:167], v26 offset:2048
    ds_read_b64_tr_b16 v[168:169], v27 offset:0
    ds_read_b64_tr_b16 v[170:171], v27 offset:2048
    ds_read_b64_tr_b16 v[172:173], v24 offset:4096
    ds_read_b64_tr_b16 v[174:175], v24 offset:6144
    ds_read_b64_tr_b16 v[176:177], v25 offset:4096
    ds_read_b64_tr_b16 v[178:179], v25 offset:6144
    ds_read_b64_tr_b16 v[180:181], v26 offset:4096
    ds_read_b64_tr_b16 v[182:183], v26 offset:6144
    ds_read_b64_tr_b16 v[184:185], v27 offset:4096
    ds_read_b64_tr_b16 v[186:187], v27 offset:6144
    s_waitcnt lgkmcnt(0)
    v_mfma_f32_16x16x32_bf16 v[28:31], v[156:159], v[60:63], 0
    ds_read_b128 v[68:71], v22 offset:0
    v_mfma_f32_16x16x32_bf16 v[32:35], v[160:163], v[60:63], 0
    ds_read_b128 v[100:103], v22 offset:8192
    v_mfma_f32_16x16x32_bf16 v[36:39], v[164:167], v[60:63], 0
    ds_read_b128 v[132:135], v22 offset:16384
    v_mfma_f32_16x16x32_bf16 v[40:43], v[168:171], v[60:63], 0
    ds_read_b128 v[72:75], v23 offset:0
    v_mfma_f32_16x16x32_bf16 v[44:47], v[156:159], v[92:95], 0
    ds_read_b128 v[104:107], v23 offset:8192
    v_mfma_f32_16x16x32_bf16 v[48:51], v[160:163], v[92:95], 0
    ds_read_b128 v[136:139], v23 offset:16384
    v_mfma_f32_16x16x32_bf16 v[52:55], v[164:167], v[92:95], 0
    v_mfma_f32_16x16x32_bf16 v[56:59], v[168:171], v[92:95], 0
    s_waitcnt vmcnt(0)
    v_mfma_f32_16x16x32_bf16 v[220:223], v[156:159], v[124:127], 0
    ds_read_b64_tr_b16 v[188:189], v24 offset:8192
    ds_read_b64_tr_b16 v[190:191], v24 offset:10240
    v_mfma_f32_16x16x32_bf16 v[224:227], v[160:163], v[124:127], 0
    ds_read_b64_tr_b16 v[192:193], v25 offset:8192
    ds_read_b64_tr_b16 v[194:195], v25 offset:10240
    v_mfma_f32_16x16x32_bf16 v[228:231], v[164:167], v[124:127], 0
    ds_read_b64_tr_b16 v[196:197], v26 offset:8192
    ds_read_b64_tr_b16 v[198:199], v26 offset:10240
    v_mfma_f32_16x16x32_bf16 v[232:235], v[168:171], v[124:127], 0
    ds_read_b64_tr_b16 v[200:201], v27 offset:8192
    ds_read_b64_tr_b16 v[202:203], v27 offset:10240
    v_mfma_f32_16x16x32_bf16 v[28:31], v[172:175], v[64:67], v[28:31]
    ds_read_b64_tr_b16 v[204:205], v24 offset:12288
    ds_read_b64_tr_b16 v[206:207], v24 offset:14336
    v_mfma_f32_16x16x32_bf16 v[32:35], v[176:179], v[64:67], v[32:35]
    ds_read_b64_tr_b16 v[208:209], v25 offset:12288
    ds_read_b64_tr_b16 v[210:211], v25 offset:14336
    v_mfma_f32_16x16x32_bf16 v[36:39], v[180:183], v[64:67], v[36:39]
    ds_read_b64_tr_b16 v[212:213], v26 offset:12288
    ds_read_b64_tr_b16 v[214:215], v26 offset:14336
    v_mfma_f32_16x16x32_bf16 v[40:43], v[184:187], v[64:67], v[40:43]
    ds_read_b64_tr_b16 v[216:217], v27 offset:12288
    ds_read_b64_tr_b16 v[218:219], v27 offset:14336
    v_mfma_f32_16x16x32_bf16 v[44:47], v[172:175], v[96:99], v[44:47]
    v_mfma_f32_16x16x32_bf16 v[48:51], v[176:179], v[96:99], v[48:51]
    v_mfma_f32_16x16x32_bf16 v[52:55], v[180:183], v[96:99], v[52:55]
    v_mfma_f32_16x16x32_bf16 v[56:59], v[184:187], v[96:99], v[56:59]
    v_mfma_f32_16x16x32_bf16 v[220:223], v[172:175], v[128:131], v[220:223]
    v_mfma_f32_16x16x32_bf16 v[224:227], v[176:179], v[128:131], v[224:227]
    v_mfma_f32_16x16x32_bf16 v[228:231], v[180:183], v[128:131], v[228:231]
    v_mfma_f32_16x16x32_bf16 v[232:235], v[184:187], v[128:131], v[232:235]
    s_waitcnt lgkmcnt(0)
    v_mfma_f32_16x16x32_bf16 v[28:31], v[188:191], v[68:71], v[28:31]
    ds_read_b128 v[76:79], v20 offset:256
    v_mfma_f32_16x16x32_bf16 v[32:35], v[192:195], v[68:71], v[32:35]
    ds_read_b128 v[108:111], v20 offset:8448
    v_mfma_f32_16x16x32_bf16 v[36:39], v[196:199], v[68:71], v[36:39]
    ds_read_b128 v[140:143], v20 offset:16640
    v_mfma_f32_16x16x32_bf16 v[40:43], v[200:203], v[68:71], v[40:43]
    ds_read_b128 v[80:83], v21 offset:256
    v_mfma_f32_16x16x32_bf16 v[44:47], v[188:191], v[100:103], v[44:47]
    ds_read_b128 v[112:115], v21 offset:8448
    v_mfma_f32_16x16x32_bf16 v[48:51], v[192:195], v[100:103], v[48:51]
    ds_read_b128 v[144:147], v21 offset:16640
    v_mfma_f32_16x16x32_bf16 v[52:55], v[196:199], v[100:103], v[52:55]
    ds_read_b128 v[84:87], v22 offset:256
    v_mfma_f32_16x16x32_bf16 v[56:59], v[200:203], v[100:103], v[56:59]
    ds_read_b128 v[116:119], v22 offset:8448
    v_mfma_f32_16x16x32_bf16 v[220:223], v[188:191], v[132:135], v[220:223]
    ds_read_b128 v[148:151], v22 offset:16640
    v_mfma_f32_16x16x32_bf16 v[224:227], v[192:195], v[132:135], v[224:227]
    ds_read_b128 v[88:91], v23 offset:256
    v_mfma_f32_16x16x32_bf16 v[228:231], v[196:199], v[132:135], v[228:231]
    ds_read_b128 v[120:123], v23 offset:8448
    v_mfma_f32_16x16x32_bf16 v[232:235], v[200:203], v[132:135], v[232:235]
    ds_read_b128 v[152:155], v23 offset:16640
    v_mfma_f32_16x16x32_bf16 v[28:31], v[204:207], v[72:75], v[28:31]
    v_mfma_f32_16x16x32_bf16 v[32:35], v[208:211], v[72:75], v[32:35]
    v_mfma_f32_16x16x32_bf16 v[36:39], v[212:215], v[72:75], v[36:39]
    v_mfma_f32_16x16x32_bf16 v[40:43], v[216:219], v[72:75], v[40:43]
    v_mfma_f32_16x16x32_bf16 v[44:47], v[204:207], v[104:107], v[44:47]
    v_mfma_f32_16x16x32_bf16 v[48:51], v[208:211], v[104:107], v[48:51]
    v_mfma_f32_16x16x32_bf16 v[52:55], v[212:215], v[104:107], v[52:55]
    v_mfma_f32_16x16x32_bf16 v[56:59], v[216:219], v[104:107], v[56:59]
    v_mfma_f32_16x16x32_bf16 v[220:223], v[204:207], v[136:139], v[220:223]
    v_mfma_f32_16x16x32_bf16 v[224:227], v[208:211], v[136:139], v[224:227]
    v_mfma_f32_16x16x32_bf16 v[228:231], v[212:215], v[136:139], v[228:231]
    v_mfma_f32_16x16x32_bf16 v[232:235], v[216:219], v[136:139], v[232:235]
    v_mov_b32 v60, 0
    v_mov_b32 v61, 0
    v_mov_b32 v62, 0
    v_mov_b32 v63, 0
    v_mov_b32 v64, 0
    v_mov_b32 v65, 0
    v_mov_b32 v66, 0
    v_mov_b32 v67, 0
    v_mov_b32 v68, 0
    v_mov_b32 v69, 0
    v_mov_b32 v70, 0
    v_mov_b32 v71, 0
    v_mov_b32 v72, 0
    v_mov_b32 v73, 0
    v_mov_b32 v74, 0
    v_mov_b32 v75, 0
    v_mov_b32 v92, 0
    v_mov_b32 v93, 0
    v_mov_b32 v94, 0
    v_mov_b32 v95, 0
    v_mov_b32 v96, 0
    v_mov_b32 v97, 0
    v_mov_b32 v98, 0
    v_mov_b32 v99, 0
    v_mov_b32 v100, 0
    v_mov_b32 v101, 0
    v_mov_b32 v102, 0
    v_mov_b32 v103, 0
    v_mov_b32 v104, 0
    v_mov_b32 v105, 0
    v_mov_b32_e64 v106, 0
    v_mov_b32 v107, 0
    s_barrier
    ds_read_b64_tr_b16 v[156:157], v24 offset:16384
    ds_read_b64_tr_b16 v[158:159], v24 offset:18432
    ds_read_b64_tr_b16 v[160:161], v25 offset:16384
    ds_read_b64_tr_b16 v[162:163], v25 offset:18432
    ds_read_b64_tr_b16 v[164:165], v26 offset:16384
    ds_read_b64_tr_b16 v[166:167], v26 offset:18432
    ds_read_b64_tr_b16 v[168:169], v27 offset:16384
    ds_read_b64_tr_b16 v[170:171], v27 offset:18432
    ds_read_b64_tr_b16 v[172:173], v24 offset:20480
    ds_read_b64_tr_b16 v[174:175], v24 offset:22528
    ds_read_b64_tr_b16 v[176:177], v25 offset:20480
    ds_read_b64_tr_b16 v[178:179], v25 offset:22528
    ds_read_b64_tr_b16 v[180:181], v26 offset:20480
    ds_read_b64_tr_b16 v[182:183], v26 offset:22528
    ds_read_b64_tr_b16 v[184:185], v27 offset:20480
    ds_read_b64_tr_b16 v[186:187], v27 offset:22528
    ds_read_b64_tr_b16 v[188:189], v24 offset:24576
    ds_read_b64_tr_b16 v[190:191], v24 offset:26624
    ds_read_b64_tr_b16 v[192:193], v25 offset:24576
    ds_read_b64_tr_b16 v[194:195], v25 offset:26624
    ds_read_b64_tr_b16 v[196:197], v26 offset:24576
    ds_read_b64_tr_b16 v[198:199], v26 offset:26624
    ds_read_b64_tr_b16 v[200:201], v27 offset:24576
    ds_read_b64_tr_b16 v[202:203], v27 offset:26624
    ds_read_b64_tr_b16 v[204:205], v24 offset:28672
    ds_read_b64_tr_b16 v[206:207], v24 offset:30720
    ds_read_b64_tr_b16 v[208:209], v25 offset:28672
    ds_read_b64_tr_b16 v[210:211], v25 offset:30720
    ds_read_b64_tr_b16 v[212:213], v26 offset:28672
    ds_read_b64_tr_b16 v[214:215], v26 offset:30720
    ds_read_b64_tr_b16 v[216:217], v27 offset:28672
    ds_read_b64_tr_b16 v[218:219], v27 offset:30720
    s_mov_b32 s46, 0x00ff00ff
    s_mov_b32 s47, 0x00ff00ff
    s_waitcnt lgkmcnt(15)
    v_mfma_f32_16x16x32_bf16 v[28:31], v[156:159], v[76:79], v[28:31]
    v_mfma_f32_16x16x32_bf16 v[32:35], v[160:163], v[76:79], v[32:35]
    v_mfma_f32_16x16x32_bf16 v[36:39], v[164:167], v[76:79], v[36:39]
    v_mfma_f32_16x16x32_bf16 v[40:43], v[168:171], v[76:79], v[40:43]
    v_mfma_f32_16x16x32_bf16 v[28:31], v[172:175], v[80:83], v[28:31]
    v_mfma_f32_16x16x32_bf16 v[32:35], v[176:179], v[80:83], v[32:35]
    v_mfma_f32_16x16x32_bf16 v[36:39], v[180:183], v[80:83], v[36:39]
    v_mfma_f32_16x16x32_bf16 v[40:43], v[184:187], v[80:83], v[40:43]
    s_waitcnt lgkmcnt(8)
    v_mfma_f32_16x16x32_bf16 v[28:31], v[188:191], v[84:87], v[28:31]
    v_mfma_f32_16x16x32_bf16 v[32:35], v[192:195], v[84:87], v[32:35]
    v_mfma_f32_16x16x32_bf16 v[36:39], v[196:199], v[84:87], v[36:39]
    v_mfma_f32_16x16x32_bf16 v[40:43], v[200:203], v[84:87], v[40:43]
    s_waitcnt lgkmcnt(0)
    v_mfma_f32_16x16x32_bf16 v[28:31], v[204:207], v[88:91], v[28:31]
    v_mfma_f32_16x16x32_bf16 v[32:35], v[208:211], v[88:91], v[32:35]
    v_mfma_f32_16x16x32_bf16 v[36:39], v[212:215], v[88:91], v[36:39]
    v_mfma_f32_16x16x32_bf16 v[40:43], v[216:219], v[88:91], v[40:43]
    s_waitcnt lgkmcnt(0)
    s_barrier
    ds_read_b32 v252, v251
    v_mfma_f32_16x16x32_bf16 v[44:47], v[156:159], v[108:111], v[44:47]
    v_mov_b32 v76, 0
    v_mov_b32_e64 v77, 0
    v_mfma_f32_16x16x32_bf16 v[48:51], v[160:163], v[108:111], v[48:51]
    v_mov_b32 v78, 0
    v_mov_b32 v79, 0
    v_mfma_f32_16x16x32_bf16 v[52:55], v[164:167], v[108:111], v[52:55]
    v_mov_b32 v80, 0
    v_mov_b32 v81, 0
    v_mfma_f32_16x16x32_bf16 v[56:59], v[168:171], v[108:111], v[56:59]
    v_mov_b32 v82, 0
    v_mov_b32 v83, 0
    v_mfma_f32_16x16x32_bf16 v[44:47], v[172:175], v[112:115], v[44:47]
    v_mov_b32 v84, 0
    v_mov_b32 v85, 0
    v_mfma_f32_16x16x32_bf16 v[48:51], v[176:179], v[112:115], v[48:51]
    v_mov_b32 v86, 0
    v_mov_b32 v87, 0
    v_mfma_f32_16x16x32_bf16 v[52:55], v[180:183], v[112:115], v[52:55]
    v_mov_b32 v88, 0
    v_mov_b32 v89, 0
    v_mfma_f32_16x16x32_bf16 v[56:59], v[184:187], v[112:115], v[56:59]
    v_mov_b32 v90, 0
    v_mov_b32 v91, 0
    v_mfma_f32_16x16x32_bf16 v[44:47], v[188:191], v[116:119], v[44:47]
    v_cvt_pk_bf16_f32 v28, v28, v29
    v_cvt_pk_bf16_f32 v29, v30, v31
    v_mfma_f32_16x16x32_bf16 v[48:51], v[192:195], v[116:119], v[48:51]
    v_cvt_pk_bf16_f32 v30, v32, v33
    v_cvt_pk_bf16_f32 v31, v34, v35
    v_mfma_f32_16x16x32_bf16 v[52:55], v[196:199], v[116:119], v[52:55]
    v_cvt_pk_bf16_f32 v36, v36, v37
    v_cvt_pk_bf16_f32 v37, v38, v39
    v_mfma_f32_16x16x32_bf16 v[56:59], v[200:203], v[116:119], v[56:59]
    v_cvt_pk_bf16_f32 v38, v40, v41
    v_cvt_pk_bf16_f32 v39, v42, v43
    v_mfma_f32_16x16x32_bf16 v[44:47], v[204:207], v[120:123], v[44:47]
    v_permlane16_swap_b32 v28, v30
    v_permlane16_swap_b32 v29, v31
    v_mfma_f32_16x16x32_bf16 v[48:51], v[208:211], v[120:123], v[48:51]
    v_permlane16_swap_b32 v36, v38
    v_permlane16_swap_b32 v37, v39
    v_mfma_f32_16x16x32_bf16 v[52:55], v[212:215], v[120:123], v[52:55]
    v_mfma_f32_16x16x32_bf16 v[56:59], v[216:219], v[120:123], v[56:59]
    v_mfma_f32_16x16x32_bf16 v[220:223], v[156:159], v[140:143], v[220:223]
    ds_write_b128 v249, v[28:31] offset:0
    ds_write_b128 v250, v[36:39] offset:0
    v_mfma_f32_16x16x32_bf16 v[224:227], v[160:163], v[140:143], v[224:227]
    v_mov_b32 v108, 0
    v_mov_b32 v109, 0
    v_mfma_f32_16x16x32_bf16 v[228:231], v[164:167], v[140:143], v[228:231]
    v_mov_b32 v110, 0
    v_mov_b32 v111, 0
    v_mfma_f32_16x16x32_bf16 v[232:235], v[168:171], v[140:143], v[232:235]
    v_mov_b32 v112, 0
    v_mov_b32 v113, 0
    v_mfma_f32_16x16x32_bf16 v[220:223], v[172:175], v[144:147], v[220:223]
    v_mov_b32 v114, 0
    v_mov_b32 v115, 0
    v_mfma_f32_16x16x32_bf16 v[224:227], v[176:179], v[144:147], v[224:227]
    v_mov_b32 v116, 0
    v_mov_b32 v117, 0
    v_mfma_f32_16x16x32_bf16 v[228:231], v[180:183], v[144:147], v[228:231]
    v_mov_b32 v118, 0
    v_mov_b32 v119, 0
    v_mfma_f32_16x16x32_bf16 v[232:235], v[184:187], v[144:147], v[232:235]
    v_mov_b32 v120, 0
    v_mov_b32 v121, 0
    v_mfma_f32_16x16x32_bf16 v[220:223], v[188:191], v[148:151], v[220:223]
    v_mov_b32 v122, 0
    v_mov_b32 v123, 0
    v_mfma_f32_16x16x32_bf16 v[224:227], v[192:195], v[148:151], v[224:227]
    v_cvt_pk_bf16_f32 v44, v44, v45
    v_cvt_pk_bf16_f32 v45, v46, v47
    v_mfma_f32_16x16x32_bf16 v[228:231], v[196:199], v[148:151], v[228:231]
    v_cvt_pk_bf16_f32 v46, v48, v49
    v_cvt_pk_bf16_f32 v47, v50, v51
    v_mfma_f32_16x16x32_bf16 v[232:235], v[200:203], v[148:151], v[232:235]
    v_cvt_pk_bf16_f32 v52, v52, v53
    v_cvt_pk_bf16_f32 v53, v54, v55
    v_mfma_f32_16x16x32_bf16 v[220:223], v[204:207], v[152:155], v[220:223]
    v_cvt_pk_bf16_f32 v54, v56, v57
    v_cvt_pk_bf16_f32 v55, v58, v59
    v_mfma_f32_16x16x32_bf16 v[224:227], v[208:211], v[152:155], v[224:227]
    v_permlane16_swap_b32 v44, v46
    v_permlane16_swap_b32 v45, v47
    v_mfma_f32_16x16x32_bf16 v[228:231], v[212:215], v[152:155], v[228:231]
    v_permlane16_swap_b32_e64 v52, v54
    v_permlane16_swap_b32 v53, v55
    v_mfma_f32_16x16x32_bf16 v[232:235], v[216:219], v[152:155], v[232:235]
    ds_write_b128 v249, v[44:47] offset:8192
    ds_write_b128 v250, v[52:55] offset:8192
    s_nop 3
    v_cvt_pk_bf16_f32 v220, v220, v221
    v_cvt_pk_bf16_f32 v221, v222, v223
    v_cvt_pk_bf16_f32 v222, v224, v225
    v_cvt_pk_bf16_f32 v223, v226, v227
    v_cvt_pk_bf16_f32 v228, v228, v229
    v_cvt_pk_bf16_f32 v229, v230, v231
    v_cvt_pk_bf16_f32 v230, v232, v233
    v_cvt_pk_bf16_f32 v231, v234, v235
    v_permlane16_swap_b32 v220, v222
    v_permlane16_swap_b32 v221, v223
    v_permlane16_swap_b32_e64 v228, v230
    v_permlane16_swap_b32 v229, v231
    s_mov_b64 exec, s[46:47]
    ds_write_b128 v249, v[220:223] offset:16384
    ds_write_b128 v250, v[228:231] offset:16384
    s_mov_b64 exec, -1
    s_waitcnt lgkmcnt(6)
    v_readlane_b32 s91, v252, 4
    v_sub_u32 v253, v252, v254
    v_lshrrev_b32 v253, 6, v253
    v_max_u32_e64 v253, 4, v253
    v_readlane_b32 s3, v252, 5
    v_readlane_b32 s37, v253, s93
    v_readlane_b32 s38, v253, 0
    v_readlane_b32 s60, v253, 1
    v_readlane_b32 s61, v253, 2
    s_or_b32 s63, s63, s3
    s_max_u32 s38, s38, s60
    v_readlane_b32 s60, v253, 3
    s_max_u32 s38, s38, s61
    s_lshl_b32 s3, s3, 8
    s_max_u32 s38, s38, s60
    s_or_b32 s3, s3, s38
    s_cmp_lg_u32 s91, 0
    s_cbranch_scc1 C_marks
    s_cmp_gt_u32 s3, 30
C_counted:
    s_cbranch_scc1 C_goslow
C_enter:
    s_mul_i32 s3, s93, 2016
    s_add_u32 s3, s3, 155648
    v_and_b32_e64 v253, 48, v1
    v_add_u32 v15, s3, v253
    s_sub_u32 s59, s38, s37
    s_cmp_lt_u32 s39, 640000
    s_cselect_b32 s3, 0x80000000, 0
    v_or_b32 v20, s3, v16
    v_or_b32 v21, s3, v17
    v_or_b32 v22, s3, v18
    v_or_b32 v23, s3, v19
    s_waitcnt lgkmcnt(0)
    v_mov_b32 v230, 0
    v_mov_b32_e64 v231, 0
    s_sub_u32 s59, s59, 1
    s_barrier
    ds_read_b128 v[28:31], v16 offset:0
    ds_read_b128 v[32:35], v17 offset:0
    ds_read_b128 v[36:39], v18 offset:0
    ds_read_b128 v[40:43], v19 offset:0
    ds_read_b128 v[44:47], v16 offset:256
    ds_read_b128 v[48:51], v17 offset:256
    ds_read_b128 v[52:55], v18 offset:256
    ds_read_b128 v[56:59], v19 offset:256
    s_cbranch_scc1 C_go
C_idle:
    s_barrier
    s_sub_u32 s59, s59, KC_1-KC_Z
    s_cbranch_scc0 C_idle
C_go:
    s_setprio 1
    ds_read_b128 v[124:127], v2 offset:16384
    ds_read_b128 v[128:131], v3 offset:16384
    ds_read_b128 v[132:135], v4 offset:16384
    ds_read_b128 v[136:139], v5 offset:16384
    ds_read_b128 v[140:143], v2 offset:16640
    ds_read_b128 v[144:147], v3 offset:16640
    ds_read_b128 v[148:151], v4 offset:16640
    ds_read_b128 v[152:155], v5 offset:16640
    ds_read_b128 v[220:223], v15 offset:0
    ds_read_b64_tr_b16 v[156:157], v6 offset:16384
    ds_read_b64_tr_b16 v[160:161], v7 offset:16384
    ds_read_b64_tr_b16 v[164:165], v8 offset:16384
    ds_read_b64_tr_b16 v[168:169], v9 offset:16384
    ds_read_b64_tr_b16 v[172:173], v10 offset:16384
    ds_read_b64_tr_b16 v[176:177], v11 offset:16384
    ds_read_b64_tr_b16 v[180:181], v12 offset:16384
    ds_read_b64_tr_b16 v[184:185], v13 offset:16384
    ds_read_b64_tr_b16 v[188:189], v6 offset:16640
    ds_read_b64_tr_b16 v[192:193], v7 offset:16640
    ds_read_b64_tr_b16 v[196:197], v8 offset:16640
    ds_read_b64_tr_b16 v[200:201], v9 offset:16640
    ds_read_b64_tr_b16 v[204:205], v10 offset:16640
    ds_read_b64_tr_b16 v[208:209], v11 offset:16640
    ds_read_b64_tr_b16 v[212:213], v12 offset:16640
    ds_read_b64_tr_b16 v[216:217], v13 offset:16640
    s_lshl_b32 s3, s37, KC_6-KC_Z
    s_sub_u32 s3, s3, 256
    v_add_u32_e64 v15, s3, v15
    s_sub_u32 s37, s37, 1
    s_waitcnt lgkmcnt(15)
    v_mfma_f32_16x16x32_bf16 v[224:227], v[124:127], v[28:31], 0
    v_mfma_f32_16x16x32_bf16 v[224:227], v[128:131], v[32:35], v[224:227]
    v_mfma_f32_16x16x32_bf16 v[224:227], v[132:135], v[36:39], v[224:227]
    v_mfma_f32_16x16x32_bf16 v[224:227], v[136:139], v[40:43], v[224:227]
    v_mfma_f32_16x16x32_bf16 v[224:227], v[140:143], v[44:47], v[224:227]
    v_cmp_eq_u32_sdwa s[40:41], v220, v14 src0_sel:BYTE_0 src1_sel:DWORD
    v_mfma_f32_16x16x32_bf16 v[224:227], v[144:147], v[48:51], v[224:227]
    v_cmp_eq_u32_sdwa s[42:43], v221, v14 src0_sel:BYTE_0 src1_sel:DWORD
    v_mfma_f32_16x16x32_bf16 v[224:227], v[148:151], v[52:55], v[224:227]
    v_cmp_eq_u32_sdwa s[44:45], v222, v14 src0_sel:BYTE_0 src1_sel:DWORD
    v_mfma_f32_16x16x32_bf16 v[224:227], v[152:155], v[56:59], v[224:227]
    v_cmp_eq_u32_sdwa s[46:47], v223, v14 src0_sel:BYTE_0 src1_sel:DWORD
    s_nop 6
    v_pk_mul_f32 v[224:225], v[224:225], s[88:89] op_sel_hi:[1,0]
    v_pk_mul_f32 v[226:227], v[226:227], s[88:89] op_sel_hi:[1,0]
    v_exp_f32 v224, v224
    v_exp_f32 v225, v225
    v_exp_f32 v226, v226
    v_exp_f32_e64 v227, v227
    v_pk_add_f32 v[224:225], v[224:225], 1.0 op_sel_hi:[1,0]
    v_pk_add_f32 v[226:227], v[226:227], 1.0 op_sel_hi:[1,0]
    v_rcp_f32 v224, v224
    v_rcp_f32 v225, v225
    v_rcp_f32 v226, v226
    v_rcp_f32 v227, v227
    v_cndmask_b32 v224, 0, v224, s[40:41]
    v_cndmask_b32 v225, 0, v225, s[42:43]
    v_cndmask_b32 v226, 0, v226, s[44:45]
    v_cndmask_b32 v227, 0, v227, s[46:47]
    v_cvt_pk_bf16_f32 v228, v224, v225
    v_cvt_pk_bf16_f32 v229, v226, v227
    s_cmp_eq_u32 s37, 0
    s_waitcnt lgkmcnt(0)
    s_cbranch_scc1 C_tail0
    s_barrier
    s_branch C_t1
    .p2align 3
C_loop:
    ds_read_b128 v[124:127], v2 offset:16384
    ds_read_b128 v[128:131], v3 offset:16384
    v_mfma_f32_16x16x32_bf16 v[60:63], v[156:159], v[228:231], v[60:63]
    ds_read_b128 v[132:135], v4 offset:16384
    v_mfma_f32_16x16x32_bf16 v[64:67], v[160:163], v[228:231], v[64:67]
    ds_read_b128 v[136:139], v5 offset:16384
    v_mfma_f32_16x16x32_bf16 v[68:71], v[164:167], v[228:231], v[68:71]
    ds_read_b128 v[140:143], v2 offset:16640
    v_mfma_f32_16x16x32_bf16 v[72:75], v[168:171], v[228:231], v[72:75]
    ds_read_b128 v[144:147], v3 offset:16640
    v_mfma_f32_16x16x32_bf16 v[76:79], v[172:175], v[228:231], v[76:79]
    ds_read_b128 v[148:151], v4 offset:16640
    v_mfma_f32_16x16x32_bf16 v[80:83], v[176:179], v[228:231], v[80:83]
    ds_read_b128 v[152:155], v5 offset:16640
    v_mfma_f32_16x16x32_bf16 v[84:87], v[180:183], v[228:231], v[84:87]
    ds_read_b128 v[220:223], v15 offset:256
    v_mfma_f32_16x16x32_bf16 v[88:91], v[184:187], v[228:231], v[88:91]
    ds_read_b64_tr_b16 v[156:157], v6 offset:16384
    s_sub_u32 s37, s37, 1
    s_waitcnt lgkmcnt(6)
    v_mfma_f32_16x16x32_bf16 v[224:227], v[124:127], v[28:31], 0
    ds_read_b64_tr_b16 v[160:161], v7 offset:16384
    ds_read_b64_tr_b16 v[164:165], v8 offset:16384
    v_mfma_f32_16x16x32_bf16 v[224:227], v[128:131], v[32:35], v[224:227]
    ds_read_b64_tr_b16 v[168:169], v9 offset:16384
    ds_read_b64_tr_b16 v[172:173], v10 offset:16384
    v_mfma_f32_16x16x32_bf16 v[224:227], v[132:135], v[36:39], v[224:227]
    ds_read_b64_tr_b16 v[176:177], v11 offset:16384
    ds_read_b64_tr_b16 v[180:181], v12 offset:16384
    v_mfma_f32_16x16x32_bf16 v[224:227], v[136:139], v[40:43], v[224:227]
    ds_read_b64_tr_b16 v[184:185], v13 offset:16384
    ds_read_b64_tr_b16 v[188:189], v6 offset:16640
    s_waitcnt lgkmcnt(10)
    v_mfma_f32_16x16x32_bf16 v[224:227], v[140:143], v[44:47], v[224:227]
    ds_read_b64_tr_b16 v[192:193], v7 offset:16640
    s_waitcnt lgkmcnt(10)
    v_cmp_eq_u32_sdwa s[40:41], v220, v14 src0_sel:BYTE_0 src1_sel:DWORD
    v_mfma_f32_16x16x32_bf16 v[224:227], v[144:147], v[48:51], v[224:227]
    v_cmp_eq_u32_sdwa s[42:43], v221, v14 src0_sel:BYTE_0 src1_sel:DWORD
    v_mfma_f32_16x16x32_bf16 v[224:227], v[148:151], v[52:55], v[224:227]
    v_cmp_eq_u32_sdwa s[44:45], v222, v14 src0_sel:BYTE_0 src1_sel:DWORD
    v_mfma_f32_16x16x32_bf16 v[224:227], v[152:155], v[56:59], v[224:227]
    v_cmp_eq_u32_sdwa s[46:47], v223, v14 src0_sel:BYTE_0 src1_sel:DWORD
    ds_read_b64_tr_b16 v[196:197], v8 offset:16640
    ds_read_b64_tr_b16 v[200:201], v9 offset:16640
    ds_read_b64_tr_b16 v[204:205], v10 offset:16640
    ds_read_b64_tr_b16 v[208:209], v11 offset:16640
    ds_read_b64_tr_b16 v[212:213], v12 offset:16640
    ds_read_b64_tr_b16 v[216:217], v13 offset:16640
    s_nop 0
    v_pk_mul_f32 v[224:225], v[224:225], s[88:89] op_sel_hi:[1,0]
    v_pk_mul_f32 v[226:227], v[226:227], s[88:89] op_sel_hi:[1,0]
    v_exp_f32 v224, v224
    v_exp_f32 v225, v225
    v_exp_f32 v226, v226
    v_exp_f32_e64 v227, v227
    v_pk_add_f32 v[224:225], v[224:225], 1.0 op_sel_hi:[1,0]
    v_pk_add_f32 v[226:227], v[226:227], 1.0 op_sel_hi:[1,0]
    v_rcp_f32 v224, v224
    v_rcp_f32 v225, v225
    v_rcp_f32 v226, v226
    v_rcp_f32 v227, v227
    v_cndmask_b32 v224, 0, v224, s[40:41]
    v_cndmask_b32 v225, 0, v225, s[42:43]
    v_cndmask_b32 v226, 0, v226, s[44:45]
    v_cndmask_b32 v227, 0, v227, s[46:47]
    v_cvt_pk_bf16_f32 v228, v224, v225
    v_cvt_pk_bf16_f32 v229, v226, v227
    s_cmp_eq_u32 s37, 0
    s_waitcnt lgkmcnt(0)
    s_cbranch_scc1 C_tail0
    s_barrier
C_t1:
    ds_read_b128 v[124:127], v2 offset:24576
    ds_read_b128 v[128:131], v3 offset:24576
    v_mfma_f32_16x16x32_bf16 v[92:95], v[188:191], v[228:231], v[92:95]
    ds_read_b128 v[132:135], v4 offset:24576
    v_mfma_f32_16x16x32_bf16 v[96:99], v[192:195], v[228:231], v[96:99]
    ds_read_b128 v[136:139], v5 offset:24576
    v_mfma_f32_16x16x32_bf16 v[100:103], v[196:199], v[228:231], v[100:103]
    ds_read_b128 v[140:143], v2 offset:24832
    v_mfma_f32_16x16x32_bf16 v[104:107], v[200:203], v[228:231], v[104:107]
    ds_read_b128 v[144:147], v3 offset:24832
    v_mfma_f32_16x16x32_bf16 v[108:111], v[204:207], v[228:231], v[108:111]
    ds_read_b128 v[148:151], v4 offset:24832
    v_mfma_f32_16x16x32_bf16 v[112:115], v[208:211], v[228:231], v[112:115]
    ds_read_b128 v[152:155], v5 offset:24832
    v_mfma_f32_16x16x32_bf16 v[116:119], v[212:215], v[228:231], v[116:119]
    ds_read_b128 v[220:223], v15 offset:192
    v_mfma_f32_16x16x32_bf16 v[120:123], v[216:219], v[228:231], v[120:123]
    ds_read_b64_tr_b16 v[190:191], v6 offset:24832
    s_sub_u32 s37, s37, 1
    s_waitcnt lgkmcnt(6)
    v_mfma_f32_16x16x32_bf16 v[224:227], v[124:127], v[28:31], 0
    ds_read_b64_tr_b16 v[194:195], v7 offset:24832
    ds_read_b64_tr_b16 v[198:199], v8 offset:24832
    v_mfma_f32_16x16x32_bf16 v[224:227], v[128:131], v[32:35], v[224:227]
    ds_read_b64_tr_b16 v[202:203], v9 offset:24832
    ds_read_b64_tr_b16 v[206:207], v10 offset:24832
    v_mfma_f32_16x16x32_bf16 v[224:227], v[132:135], v[36:39], v[224:227]
    ds_read_b64_tr_b16 v[210:211], v11 offset:24832
    ds_read_b64_tr_b16 v[214:215], v12 offset:24832
    v_mfma_f32_16x16x32_bf16 v[224:227], v[136:139], v[40:43], v[224:227]
    ds_read_b64_tr_b16 v[218:219], v13 offset:24832
    ds_read_b64_tr_b16 v[158:159], v6 offset:24576
    s_waitcnt lgkmcnt(10)
    v_mfma_f32_16x16x32_bf16 v[224:227], v[140:143], v[44:47], v[224:227]
    ds_read_b64_tr_b16 v[162:163], v7 offset:24576
    s_waitcnt lgkmcnt(10)
    v_cmp_eq_u32_sdwa s[40:41], v220, v14 src0_sel:BYTE_0 src1_sel:DWORD
    v_mfma_f32_16x16x32_bf16 v[224:227], v[144:147], v[48:51], v[224:227]
    v_cmp_eq_u32_sdwa s[42:43], v221, v14 src0_sel:BYTE_0 src1_sel:DWORD
    v_mfma_f32_16x16x32_bf16 v[224:227], v[148:151], v[52:55], v[224:227]
    v_cmp_eq_u32_sdwa s[44:45], v222, v14 src0_sel:BYTE_0 src1_sel:DWORD
    v_mfma_f32_16x16x32_bf16 v[224:227], v[152:155], v[56:59], v[224:227]
    v_cmp_eq_u32_sdwa s[46:47], v223, v14 src0_sel:BYTE_0 src1_sel:DWORD
    ds_read_b64_tr_b16 v[166:167], v8 offset:24576
    ds_read_b64_tr_b16 v[170:171], v9 offset:24576
    ds_read_b64_tr_b16 v[174:175], v10 offset:24576
    ds_read_b64_tr_b16 v[178:179], v11 offset:24576
    ds_read_b64_tr_b16 v[182:183], v12 offset:24576
    ds_read_b64_tr_b16 v[186:187], v13 offset:24576
    s_nop 0
    v_pk_mul_f32 v[224:225], v[224:225], s[88:89] op_sel_hi:[1,0]
    v_pk_mul_f32 v[226:227], v[226:227], s[88:89] op_sel_hi:[1,0]
    v_exp_f32 v224, v224
    v_exp_f32 v225, v225
    v_exp_f32 v226, v226
    v_exp_f32_e64 v227, v227
    v_pk_add_f32 v[224:225], v[224:225], 1.0 op_sel_hi:[1,0]
    v_pk_add_f32 v[226:227], v[226:227], 1.0 op_sel_hi:[1,0]
    v_rcp_f32 v224, v224
    v_rcp_f32 v225, v225
    v_rcp_f32 v226, v226
    v_rcp_f32 v227, v227
    v_cndmask_b32 v224, 0, v224, s[40:41]
    v_cndmask_b32 v225, 0, v225, s[42:43]
    v_cndmask_b32 v226, 0, v226, s[44:45]
    v_cndmask_b32 v227, 0, v227, s[46:47]
    v_cvt_pk_bf16_f32 v230, v224, v225
    v_cvt_pk_bf16_f32 v231, v226, v227
    s_cmp_eq_u32 s37, 0
    s_waitcnt lgkmcnt(0)
    s_cbranch_scc1 C_tail1
    s_barrier
    ds_read_b128 v[124:127], v2 offset:0
    ds_read_b128 v[128:131], v3 offset:0
    v_mfma_f32_16x16x32_bf16 v[60:63], v[156:159], v[228:231], v[60:63]
    ds_read_b128 v[132:135], v4 offset:0
    v_mfma_f32_16x16x32_bf16 v[64:67], v[160:163], v[228:231], v[64:67]
    ds_read_b128 v[136:139], v5 offset:0
    v_mfma_f32_16x16x32_bf16 v[68:71], v[164:167], v[228:231], v[68:71]
    ds_read_b128 v[140:143], v2 offset:256
    v_mfma_f32_16x16x32_bf16 v[72:75], v[168:171], v[228:231], v[72:75]
    ds_read_b128 v[144:147], v3 offset:256
    v_mfma_f32_16x16x32_bf16 v[76:79], v[172:175], v[228:231], v[76:79]
    ds_read_b128 v[148:151], v4 offset:256
    v_mfma_f32_16x16x32_bf16 v[80:83], v[176:179], v[228:231], v[80:83]
    ds_read_b128 v[152:155], v5 offset:256
    v_mfma_f32_16x16x32_bf16 v[84:87], v[180:183], v[228:231], v[84:87]
    ds_read_b128 v[220:223], v15 offset:128
    v_mfma_f32_16x16x32_bf16 v[88:91], v[184:187], v[228:231], v[88:91]
    ds_read_b64_tr_b16 v[156:157], v6 offset:0
    s_sub_u32 s37, s37, 1
    s_waitcnt lgkmcnt(6)
    v_mfma_f32_16x16x32_bf16 v[224:227], v[124:127], v[28:31], 0
    ds_read_b64_tr_b16 v[160:161], v7 offset:0
    ds_read_b64_tr_b16 v[164:165], v8 offset:0
    v_mfma_f32_16x16x32_bf16 v[224:227], v[128:131], v[32:35], v[224:227]
    ds_read_b64_tr_b16 v[168:169], v9 offset:0
    ds_read_b64_tr_b16 v[172:173], v10 offset:0
    v_mfma_f32_16x16x32_bf16 v[224:227], v[132:135], v[36:39], v[224:227]
    ds_read_b64_tr_b16 v[176:177], v11 offset:0
    ds_read_b64_tr_b16 v[180:181], v12 offset:0
    v_mfma_f32_16x16x32_bf16 v[224:227], v[136:139], v[40:43], v[224:227]
    ds_read_b64_tr_b16 v[184:185], v13 offset:0
    ds_read_b64_tr_b16 v[188:189], v6 offset:256
    s_waitcnt lgkmcnt(10)
    v_mfma_f32_16x16x32_bf16 v[224:227], v[140:143], v[44:47], v[224:227]
    ds_read_b64_tr_b16 v[192:193], v7 offset:256
    s_waitcnt lgkmcnt(10)
    v_cmp_eq_u32_sdwa s[40:41], v220, v14 src0_sel:BYTE_0 src1_sel:DWORD
    v_mfma_f32_16x16x32_bf16 v[224:227], v[144:147], v[48:51], v[224:227]
    v_cmp_eq_u32_sdwa s[42:43], v221, v14 src0_sel:BYTE_0 src1_sel:DWORD
    v_mfma_f32_16x16x32_bf16 v[224:227], v[148:151], v[52:55], v[224:227]
    v_cmp_eq_u32_sdwa s[44:45], v222, v14 src0_sel:BYTE_0 src1_sel:DWORD
    v_mfma_f32_16x16x32_bf16 v[224:227], v[152:155], v[56:59], v[224:227]
    v_cmp_eq_u32_sdwa s[46:47], v223, v14 src0_sel:BYTE_0 src1_sel:DWORD
    ds_read_b64_tr_b16 v[196:197], v8 offset:256
    ds_read_b64_tr_b16 v[200:201], v9 offset:256
    ds_read_b64_tr_b16 v[204:205], v10 offset:256
    ds_read_b64_tr_b16 v[208:209], v11 offset:256
    ds_read_b64_tr_b16 v[212:213], v12 offset:256
    ds_read_b64_tr_b16 v[216:217], v13 offset:256
    s_nop 0
    v_pk_mul_f32 v[224:225], v[224:225], s[88:89] op_sel_hi:[1,0]
    v_pk_mul_f32 v[226:227], v[226:227], s[88:89] op_sel_hi:[1,0]
    v_exp_f32 v224, v224
    v_exp_f32 v225, v225
    v_exp_f32 v226, v226
    v_exp_f32_e64 v227, v227
    v_pk_add_f32 v[224:225], v[224:225], 1.0 op_sel_hi:[1,0]
    v_pk_add_f32 v[226:227], v[226:227], 1.0 op_sel_hi:[1,0]
    v_rcp_f32 v224, v224
    v_rcp_f32 v225, v225
    v_rcp_f32 v226, v226
    v_rcp_f32 v227, v227
    v_cndmask_b32 v224, 0, v224, s[40:41]
    v_cndmask_b32 v225, 0, v225, s[42:43]
    v_cndmask_b32 v226, 0, v226, s[44:45]
    v_cndmask_b32 v227, 0, v227, s[46:47]
    v_cvt_pk_bf16_f32 v228, v224, v225
    v_cvt_pk_bf16_f32 v229, v226, v227
    s_cmp_eq_u32 s37, 0
    s_waitcnt lgkmcnt(0)
    s_cbranch_scc1 C_tail0
    s_barrier
    ds_read_b128 v[124:127], v2 offset:8192
    ds_read_b128 v[128:131], v3 offset:8192
    v_mfma_f32_16x16x32_bf16 v[92:95], v[188:191], v[228:231], v[92:95]
    ds_read_b128 v[132:135], v4 offset:8192
    v_mfma_f32_16x16x32_bf16 v[96:99], v[192:195], v[228:231], v[96:99]
    ds_read_b128 v[136:139], v5 offset:8192
    v_mfma_f32_16x16x32_bf16 v[100:103], v[196:199], v[228:231], v[100:103]
    ds_read_b128 v[140:143], v2 offset:8448
    v_mfma_f32_16x16x32_bf16 v[104:107], v[200:203], v[228:231], v[104:107]
    ds_read_b128 v[144:147], v3 offset:8448
    v_mfma_f32_16x16x32_bf16 v[108:111], v[204:207], v[228:231], v[108:111]
    ds_read_b128 v[148:151], v4 offset:8448
    v_mfma_f32_16x16x32_bf16 v[112:115], v[208:211], v[228:231], v[112:115]
    ds_read_b128 v[152:155], v5 offset:8448
    v_mfma_f32_16x16x32_bf16 v[116:119], v[212:215], v[228:231], v[116:119]
    ds_read_b128 v[220:223], v15 offset:64
    v_mfma_f32_16x16x32_bf16 v[120:123], v[216:219], v[228:231], v[120:123]
    ds_read_b64_tr_b16 v[190:191], v6 offset:8448
    s_sub_u32 s37, s37, 1
    s_waitcnt lgkmcnt(6)
    v_mfma_f32_16x16x32_bf16 v[224:227], v[124:127], v[28:31], 0
    ds_read_b64_tr_b16 v[194:195], v7 offset:8448
    ds_read_b64_tr_b16 v[198:199], v8 offset:8448
    v_mfma_f32_16x16x32_bf16 v[224:227], v[128:131], v[32:35], v[224:227]
    ds_read_b64_tr_b16 v[202:203], v9 offset:8448
    ds_read_b64_tr_b16 v[206:207], v10 offset:8448
    v_mfma_f32_16x16x32_bf16 v[224:227], v[132:135], v[36:39], v[224:227]
    ds_read_b64_tr_b16 v[210:211], v11 offset:8448
    ds_read_b64_tr_b16 v[214:215], v12 offset:8448
    v_mfma_f32_16x16x32_bf16 v[224:227], v[136:139], v[40:43], v[224:227]
    ds_read_b64_tr_b16 v[218:219], v13 offset:8448
    ds_read_b64_tr_b16 v[158:159], v6 offset:8192
    s_waitcnt lgkmcnt(10)
    v_mfma_f32_16x16x32_bf16 v[224:227], v[140:143], v[44:47], v[224:227]
    ds_read_b64_tr_b16 v[162:163], v7 offset:8192
    s_waitcnt lgkmcnt(10)
    v_cmp_eq_u32_sdwa s[40:41], v220, v14 src0_sel:BYTE_0 src1_sel:DWORD
    v_mfma_f32_16x16x32_bf16 v[224:227], v[144:147], v[48:51], v[224:227]
    v_cmp_eq_u32_sdwa s[42:43], v221, v14 src0_sel:BYTE_0 src1_sel:DWORD
    v_mfma_f32_16x16x32_bf16 v[224:227], v[148:151], v[52:55], v[224:227]
    v_cmp_eq_u32_sdwa s[44:45], v222, v14 src0_sel:BYTE_0 src1_sel:DWORD
    v_mfma_f32_16x16x32_bf16 v[224:227], v[152:155], v[56:59], v[224:227]
    v_cmp_eq_u32_sdwa s[46:47], v223, v14 src0_sel:BYTE_0 src1_sel:DWORD
    ds_read_b64_tr_b16 v[166:167], v8 offset:8192
    ds_read_b64_tr_b16 v[170:171], v9 offset:8192
    ds_read_b64_tr_b16 v[174:175], v10 offset:8192
    ds_read_b64_tr_b16 v[178:179], v11 offset:8192
    ds_read_b64_tr_b16 v[182:183], v12 offset:8192
    ds_read_b64_tr_b16 v[186:187], v13 offset:8192
    s_nop 0
    v_pk_mul_f32 v[224:225], v[224:225], s[88:89] op_sel_hi:[1,0]
    v_pk_mul_f32 v[226:227], v[226:227], s[88:89] op_sel_hi:[1,0]
    v_exp_f32 v224, v224
    v_exp_f32 v225, v225
    v_exp_f32 v226, v226
    v_exp_f32_e64 v227, v227
    v_pk_add_f32 v[224:225], v[224:225], 1.0 op_sel_hi:[1,0]
    v_pk_add_f32 v[226:227], v[226:227], 1.0 op_sel_hi:[1,0]
    v_rcp_f32 v224, v224
    v_rcp_f32 v225, v225
    v_rcp_f32 v226, v226
    v_rcp_f32 v227, v227
    v_cndmask_b32 v224, 0, v224, s[40:41]
    v_cndmask_b32 v225, 0, v225, s[42:43]
    v_cndmask_b32 v226, 0, v226, s[44:45]
    v_cndmask_b32 v227, 0, v227, s[46:47]
    v_cvt_pk_bf16_f32 v230, v224, v225
    v_cvt_pk_bf16_f32 v231, v226, v227
    v_subrev_u32 v15, 256, v15
    s_cmp_eq_u32 s37, 0
    s_waitcnt lgkmcnt(0)
    s_cbranch_scc1 C_tail1
    s_barrier
    s_branch C_loop
C_tail0:
    v_mov_b32 v222, 0
    v_mov_b32 v223, 0
    v_mov_b32 v220, v228
    v_mov_b32 v221, v229
    v_mfma_f32_16x16x32_bf16 v[92:95], v[188:191], v[228:231], v[92:95]
    v_mfma_f32_16x16x32_bf16 v[96:99], v[192:195], v[228:231], v[96:99]
    v_mfma_f32_16x16x32_bf16 v[100:103], v[196:199], v[228:231], v[100:103]
    v_mfma_f32_16x16x32_bf16 v[104:107], v[200:203], v[228:231], v[104:107]
    v_mfma_f32_16x16x32_bf16 v[108:111], v[204:207], v[228:231], v[108:111]
    v_mfma_f32_16x16x32_bf16 v[112:115], v[208:211], v[228:231], v[112:115]
    v_mfma_f32_16x16x32_bf16 v[116:119], v[212:215], v[228:231], v[116:119]
    v_mfma_f32_16x16x32_bf16 v[120:123], v[216:219], v[228:231], v[120:123]
    s_nop 0
    v_mfma_f32_16x16x32_bf16 v[60:63], v[156:159], v[220:223], v[60:63]
    v_cvt_pk_bf16_f32 v44, v92, v93
    v_cvt_pk_bf16_f32 v45, v94, v95
    v_mfma_f32_16x16x32_bf16 v[64:67], v[160:163], v[220:223], v[64:67]
    v_cvt_pk_bf16_f32 v46, v96, v97
    v_cvt_pk_bf16_f32 v47, v98, v99
    v_mfma_f32_16x16x32_bf16 v[68:71], v[164:167], v[220:223], v[68:71]
    ds_write_b128 v20, v[44:47] offset:256
    v_cvt_pk_bf16_f32 v48, v100, v101
    v_mfma_f32_16x16x32_bf16 v[72:75], v[168:171], v[220:223], v[72:75]
    v_cvt_pk_bf16_f32 v49, v102, v103
    v_cvt_pk_bf16_f32 v50, v104, v105
    v_mfma_f32_16x16x32_bf16 v[76:79], v[172:175], v[220:223], v[76:79]
    v_cvt_pk_bf16_f32 v51, v106, v107
    ds_write_b128 v21, v[48:51] offset:256
    v_mfma_f32_16x16x32_bf16 v[80:83], v[176:179], v[220:223], v[80:83]
    v_cvt_pk_bf16_f32 v52, v108, v109
    v_cvt_pk_bf16_f32 v53, v110, v111
    v_mfma_f32_16x16x32_bf16 v[84:87], v[180:183], v[220:223], v[84:87]
    v_cvt_pk_bf16_f32 v54, v112, v113
    v_cvt_pk_bf16_f32 v55, v114, v115
    v_mfma_f32_16x16x32_bf16 v[88:91], v[184:187], v[220:223], v[88:91]
    ds_write_b128 v22, v[52:55] offset:256
    v_cvt_pk_bf16_f32 v56, v116, v117
    v_cvt_pk_bf16_f32 v57, v118, v119
    v_cvt_pk_bf16_f32 v58, v120, v121
    v_cvt_pk_bf16_f32 v59, v122, v123
    ds_write_b128 v23, v[56:59] offset:256
    v_cvt_pk_bf16_f32 v28, v60, v61
    v_cvt_pk_bf16_f32 v29, v62, v63
    v_cvt_pk_bf16_f32 v30, v64, v65
    v_cvt_pk_bf16_f32 v31, v66, v67
    ds_write_b128 v20, v[28:31] offset:0
    v_cvt_pk_bf16_f32 v32, v68, v69
    v_cvt_pk_bf16_f32 v33, v70, v71
    v_cvt_pk_bf16_f32 v34, v72, v73
    v_cvt_pk_bf16_f32 v35, v74, v75
    ds_write_b128 v21, v[32:35] offset:0
    v_cvt_pk_bf16_f32 v36, v76, v77
    v_cvt_pk_bf16_f32 v37, v78, v79
    v_cvt_pk_bf16_f32 v38, v80, v81
    v_cvt_pk_bf16_f32 v39, v82, v83
    ds_write_b128 v22, v[36:39] offset:0
    v_cvt_pk_bf16_f32 v40, v84, v85
    v_cvt_pk_bf16_f32 v41, v86, v87
    v_cvt_pk_bf16_f32 v42, v88, v89
    v_cvt_pk_bf16_f32 v43, v90, v91
    ds_write_b128 v23, v[40:43] offset:0
    s_branch C_dumped
C_tail1:
    v_mov_b32 v220, 0
    v_mov_b32 v221, 0
    v_mov_b32 v222, v230
    v_mov_b32 v223, v231
    v_mfma_f32_16x16x32_bf16 v[60:63], v[156:159], v[228:231], v[60:63]
    v_mfma_f32_16x16x32_bf16 v[64:67], v[160:163], v[228:231], v[64:67]
    v_mfma_f32_16x16x32_bf16 v[68:71], v[164:167], v[228:231], v[68:71]
    v_mfma_f32_16x16x32_bf16 v[72:75], v[168:171], v[228:231], v[72:75]
    v_mfma_f32_16x16x32_bf16 v[76:79], v[172:175], v[228:231], v[76:79]
    v_mfma_f32_16x16x32_bf16 v[80:83], v[176:179], v[228:231], v[80:83]
    v_mfma_f32_16x16x32_bf16 v[84:87], v[180:183], v[228:231], v[84:87]
    v_mfma_f32_16x16x32_bf16 v[88:91], v[184:187], v[228:231], v[88:91]
    s_nop 0
    v_mfma_f32_16x16x32_bf16 v[92:95], v[188:191], v[220:223], v[92:95]
    v_cvt_pk_bf16_f32 v28, v60, v61
    v_cvt_pk_bf16_f32 v29, v62, v63
    v_mfma_f32_16x16x32_bf16 v[96:99], v[192:195], v[220:223], v[96:99]
    v_cvt_pk_bf16_f32 v30, v64, v65
    v_cvt_pk_bf16_f32 v31, v66, v67
    v_mfma_f32_16x16x32_bf16 v[100:103], v[196:199], v[220:223], v[100:103]
    ds_write_b128 v20, v[28:31] offset:0
    v_cvt_pk_bf16_f32 v32, v68, v69
    v_mfma_f32_16x16x32_bf16 v[104:107], v[200:203], v[220:223], v[104:107]
    v_cvt_pk_bf16_f32 v33, v70, v71
    v_cvt_pk_bf16_f32 v34, v72, v73
    v_mfma_f32_16x16x32_bf16 v[108:111], v[204:207], v[220:223], v[108:111]
    v_cvt_pk_bf16_f32 v35, v74, v75
    ds_write_b128 v21, v[32:35] offset:0
    v_mfma_f32_16x16x32_bf16 v[112:115], v[208:211], v[220:223], v[112:115]
    v_cvt_pk_bf16_f32 v36, v76, v77
    v_cvt_pk_bf16_f32 v37, v78, v79
    v_mfma_f32_16x16x32_bf16 v[116:119], v[212:215], v[220:223], v[116:119]
    v_cvt_pk_bf16_f32 v38, v80, v81
    v_cvt_pk_bf16_f32 v39, v82, v83
    v_mfma_f32_16x16x32_bf16 v[120:123], v[216:219], v[220:223], v[120:123]
    ds_write_b128 v22, v[36:39] offset:0
    v_cvt_pk_bf16_f32 v40, v84, v85
    v_cvt_pk_bf16_f32 v41, v86, v87
    v_cvt_pk_bf16_f32 v42, v88, v89
    v_cvt_pk_bf16_f32 v43, v90, v91
    ds_write_b128 v23, v[40:43] offset:0
    v_cvt_pk_bf16_f32 v44, v92, v93
    v_cvt_pk_bf16_f32 v45, v94, v95
    v_cvt_pk_bf16_f32 v46, v96, v97
    v_cvt_pk_bf16_f32 v47, v98, v99
    ds_write_b128 v20, v[44:47] offset:256
    v_cvt_pk_bf16_f32 v48, v100, v101
    v_cvt_pk_bf16_f32 v49, v102, v103
    v_cvt_pk_bf16_f32 v50, v104, v105
    v_cvt_pk_bf16_f32 v51, v106, v107
    ds_write_b128 v21, v[48:51] offset:256
    v_cvt_pk_bf16_f32 v52, v108, v109
    v_cvt_pk_bf16_f32 v53, v110, v111
    v_cvt_pk_bf16_f32 v54, v112, v113
    v_cvt_pk_bf16_f32 v55, v114, v115
    ds_write_b128 v22, v[52:55] offset:256
    v_cvt_pk_bf16_f32 v56, v116, v117
    v_cvt_pk_bf16_f32 v57, v118, v119
    v_cvt_pk_bf16_f32 v58, v120, v121
    v_cvt_pk_bf16_f32 v59, v122, v123
    ds_write_b128 v23, v[56:59] offset:256
C_dumped:
    s_cmp_lt_u32 s39, 640000
    s_waitcnt lgkmcnt(0)
    s_barrier
    s_cbranch_scc1 C_slow
    s_or_b32 s3, s2, s93
    s_cbranch_scc1 C_nostate
    s_add_u32 s52, s52, 0x9e3779b9
    s_add_u32 s53, s53, 0x7f4a7c15
    s_mov_b64 exec, 1
    v_mov_b32 v2, 4194304
    v_mov_b32 v4, s52
    v_mov_b32 v5, s53
    global_store_dwordx2 v2, v[4:5], s[18:19] sc1
C_nostate:
    s_endpgm
    s_nop 0
L_repoll:
    s_mov_b32 s44, 0xf0000103
    v_or3_b32 v28, v20, v21, v22
    v_bitop3_b32 v28, v28, v23, s44 bitop3:0xa8
    v_cmp_ne_u32_e64 vcc, 0, v28
    s_wqm_b64 vcc, vcc
    s_andn2_b64 exec, s[48:49], vcc
    s_cbranch_scc0 L_no5th0
    s_and_b64 s[48:49], s[48:49], vcc
    v_bfe_u32 v28, v20, 23, 5
    v_bfe_u32 v29, v21, 23, 5
    v_lshl_or_b32 v28, v29, 5, v28
    v_bfe_u32 v29, v22, 23, 5
    v_lshl_or_b32 v28, v29, 10, v28
    v_bfe_u32 v29, v23, 23, 5
    v_lshl_or_b32 v28, v29, 15, v28
    v_not_b32_e64 v28, v28
    v_bfe_u32 v29, v28, 6, 14
    v_and_b32 v28, 63, v28
    v_lshlrev_b32 v28, 2, v28
    v_lshl_or_b32 v28, v29, 9, v28
    v_and_b32_e64 v29, 12, v28
    ds_add_rtn_u32 v29, v29, v3
    v_and_b32 v20, 0x7fffff, v20
    v_and_b32 v21, 0x7fffff, v21
    v_and_b32 v22, 0x7fffff, v22
    v_and_b32 v23, 0x7fffff, v23
    s_waitcnt lgkmcnt(0)
    ds_write_b32 v29, v28
L_no5th0:
    s_mov_b64 exec, -1
    v_or3_b32 v28, v24, v25, v26
    v_bitop3_b32 v28, v28, v27, s44 bitop3:0xa8
    v_cmp_ne_u32_e64 vcc, 0, v28
    s_wqm_b64 vcc, vcc
    s_andn2_b64 exec, s[50:51], vcc
    s_cbranch_scc0 L_no5th1
    s_and_b64 s[50:51], s[50:51], vcc
    v_bfe_u32 v28, v24, 23, 5
    v_bfe_u32 v29, v25, 23, 5
    v_lshl_or_b32 v28, v29, 5, v28
    v_bfe_u32 v29, v26, 23, 5
    v_lshl_or_b32 v28, v29, 10, v28
    v_bfe_u32 v29, v27, 23, 5
    v_lshl_or_b32 v28, v29, 15, v28
    v_not_b32_e64 v28, v28
    v_bfe_u32 v29, v28, 6, 14
    v_and_b32 v28, 63, v28
    v_lshlrev_b32 v28, 2, v28
    v_lshl_or_b32 v28, v29, 9, v28
    v_and_b32_e64 v29, 12, v28
    ds_add_rtn_u32 v29, v29, v3
    v_and_b32 v24, 0x7fffff, v24
    v_and_b32 v25, 0x7fffff, v25
    v_and_b32 v26, 0x7fffff, v26
    v_and_b32 v27, 0x7fffff, v27
    s_waitcnt lgkmcnt(0)
    ds_write_b32 v29, v28
L_no5th1:
    s_mov_b64 exec, -1
    s_or_b64 vcc, s[48:49], s[50:51]
    s_cbranch_scc0 L_polled
    s_cmp_eq_u32 s2, KC_0-KC_Z
    s_cselect_b32 s44, 1, 128
    s_add_u32 s3, s3, s44
    s_cmp_gt_u32 s3, 512000
    s_cbranch_scc1 L_timeout
    s_mov_b64 exec, s[48:49]
    s_cbranch_execz L_repoll1
    global_load_dwordx4 v[20:23], v36, s[18:19] sc1
L_repoll1:
    s_mov_b64 exec, s[50:51]
    s_cbranch_execz L_repoll2
    global_load_dwordx4 v[24:27], v37, s[18:19] sc1
L_repoll2:
    s_waitcnt vmcnt(0)
    s_branch L_poll
L_timeout:
    v_bfrev_b32 v20, 1
    v_bfrev_b32 v21, 1
    v_bfrev_b32 v22, 1
    v_bfrev_b32 v23, 1
    v_bfrev_b32 v24, 1
    v_bfrev_b32 v25, 1
    v_bfrev_b32 v26, 1
    v_bfrev_b32 v27, 1
    ds_write_b32 v3, v3 offset:16
    s_branch L_polled
    s_nop 0
L_spill:
    ds_write_b32 v3, v3 offset:28
    v_sub_u32 v230, -4, v60
    v_lshrrev_b32 v231, 6, v84
    v_lshl_add_u32 v231, v231, 4, v230
    v_cmpx_gt_u32 vcc, 16, v230
    ds_write_b32 v231, v52 offset:51200
    s_mov_b64 exec, -1
    v_sub_u32 v230, -4, v61
    v_lshrrev_b32 v231, 6, v85
    v_lshl_add_u32 v231, v231, 4, v230
    v_cmpx_gt_u32 vcc, 16, v230
    ds_write_b32 v231, v53 offset:51200
    s_mov_b64 exec, -1
    v_sub_u32 v230, -4, v62
    v_lshrrev_b32 v231, 6, v86
    v_lshl_add_u32 v231, v231, 4, v230
    v_cmpx_gt_u32 vcc, 16, v230
    ds_write_b32 v231, v54 offset:51200
    s_mov_b64 exec, -1
    v_sub_u32 v230, -4, v63
    v_lshrrev_b32 v231, 6, v87
    v_lshl_add_u32 v231, v231, 4, v230
    v_cmpx_gt_u32 vcc, 16, v230
    ds_write_b32 v231, v55 offset:51200
    s_mov_b64 exec, -1
    v_sub_u32 v230, -4, v64
    v_lshrrev_b32 v231, 6, v88
    v_lshl_add_u32 v231, v231, 4, v230
    v_cmpx_gt_u32 vcc, 16, v230
    ds_write_b32 v231, v56 offset:51200
    s_mov_b64 exec, -1
    s_branch L_spilled
    s_nop 0
L_overflow:
    v_and_b32 v230, 0xfc, v0
    v_and_b32 v231, 3, v0
    v_cmp_eq_u32 vcc, 0, v231
    v_lshlrev_b32_e64 v232, 4, v230
    v_lshl_add_u32 v52, v231, 2, 64
    v_cndmask_b32 v231, 0, v3, vcc
    v_lshlrev_b32 v53, 2, v0
    ds_read_b32 v233, v230 offset:1024
    ds_read_b32 v54, v53 offset:51200
    v_or_b32 v121, v231, v68
    s_waitcnt lgkmcnt(0)
    v_sub_u32 v233, v233, v232
    v_cmp_gt_u32 vcc, v233, v52
    v_bfe_u32 v55, v54, 2, 6
    v_lshrrev_b32_e64 v54, 9, v54
    v_lshl_or_b32 v54, v54, 6, v55
    v_not_b32 v54, v54
    v_cndmask_b32 v54, 0, v54, vcc
    v_cmp_lt_u32 vcc, 80, v233
    v_add_u32 v232, 0x1000, v232
    v_bfe_u32 v55, v54, 0, 5
    v_lshl_or_b32 v100, v55, 23, v100
    v_cndmask_b32_e64 v100, v100, v121, vcc
    v_bfe_u32 v55, v54, 5, 5
    v_lshl_or_b32 v101, v55, 23, v101
    v_cndmask_b32_e64 v101, v101, v68, vcc
    v_bfe_u32 v55, v54, 10, 5
    v_lshl_or_b32 v102, v55, 23, v102
    v_cndmask_b32_e64 v102, v102, v68, vcc
    v_bfe_u32 v55, v54, 15, 5
    v_lshl_or_b32 v103, v55, 23, v103
    v_cndmask_b32_e64 v103, v103, v68, vcc
    ds_read_b32 v233, v230 offset:1280
    ds_read_b32 v54, v53 offset:52224
    v_or_b32 v121, v231, v72
    s_waitcnt lgkmcnt(0)
    v_sub_u32 v233, v233, v232
    v_cmp_gt_u32 vcc, v233, v52
    v_bfe_u32 v55, v54, 2, 6
    v_lshrrev_b32_e64 v54, 9, v54
    v_lshl_or_b32 v54, v54, 6, v55
    v_not_b32 v54, v54
    v_cndmask_b32 v54, 0, v54, vcc
    v_cmp_lt_u32 vcc, 80, v233
    v_add_u32 v232, 0x1000, v232
    v_bfe_u32 v55, v54, 0, 5
    v_lshl_or_b32 v104, v55, 23, v104
    v_cndmask_b32_e64 v104, v104, v121, vcc
    v_bfe_u32 v55, v54, 5, 5
    v_lshl_or_b32 v105, v55, 23, v105
    v_cndmask_b32_e64 v105, v105, v72, vcc
    v_bfe_u32 v55, v54, 10, 5
    v_lshl_or_b32 v106, v55, 23, v106
    v_cndmask_b32_e64 v106, v106, v72, vcc
    v_bfe_u32 v55, v54, 15, 5
    v_lshl_or_b32 v107, v55, 23, v107
    v_cndmask_b32_e64 v107, v107, v72, vcc
    ds_read_b32 v233, v230 offset:1536
    ds_read_b32 v54, v53 offset:53248
    v_or_b32 v121, v231, v76
    s_waitcnt lgkmcnt(0)
    v_sub_u32 v233, v233, v232
    v_cmp_gt_u32 vcc, v233, v52
    v_bfe_u32 v55, v54, 2, 6
    v_lshrrev_b32_e64 v54, 9, v54
    v_lshl_or_b32 v54, v54, 6, v55
    v_not_b32 v54, v54
    v_cndmask_b32 v54, 0, v54, vcc
    v_cmp_lt_u32 vcc, 80, v233
    v_add_u32 v232, 0x1000, v232
    v_bfe_u32 v55, v54, 0, 5
    v_lshl_or_b32 v108, v55, 23, v108
    v_cndmask_b32_e64 v108, v108, v121, vcc
    v_bfe_u32 v55, v54, 5, 5
    v_lshl_or_b32 v109, v55, 23, v109
    v_cndmask_b32_e64 v109, v109, v76, vcc
    v_bfe_u32 v55, v54, 10, 5
    v_lshl_or_b32 v110, v55, 23, v110
    v_cndmask_b32_e64 v110, v110, v76, vcc
    v_bfe_u32 v55, v54, 15, 5
    v_lshl_or_b32 v111, v55, 23, v111
    v_cndmask_b32_e64 v111, v111, v76, vcc
    ds_read_b32 v233, v230 offset:1792
    ds_read_b32 v54, v53 offset:54272
    v_or_b32 v121, v231, v80
    s_waitcnt lgkmcnt(0)
    v_sub_u32 v233, v233, v232
    v_cmp_gt_u32 vcc, v233, v52
    v_bfe_u32 v55, v54, 2, 6
    v_lshrrev_b32_e64 v54, 9, v54
    v_lshl_or_b32 v54, v54, 6, v55
    v_not_b32 v54, v54
    v_cndmask_b32 v54, 0, v54, vcc
    v_cmp_lt_u32 vcc, 80, v233
    v_add_u32 v232, 0x1000, v232
    v_bfe_u32 v55, v54, 0, 5
    v_lshl_or_b32 v112, v55, 23, v112
    v_cndmask_b32_e64 v112, v112, v121, vcc
    v_bfe_u32 v55, v54, 5, 5
    v_lshl_or_b32 v113, v55, 23, v113
    v_cndmask_b32_e64 v113, v113, v80, vcc
    v_bfe_u32 v55, v54, 10, 5
    v_lshl_or_b32 v114, v55, 23, v114
    v_cndmask_b32_e64 v114, v114, v80, vcc
    v_bfe_u32 v55, v54, 15, 5
    v_lshl_or_b32 v115, v55, 23, v115
    v_cndmask_b32 v115, v115, v80, vcc
    s_branch L_publish
    s_nop 0
L_mark:
    s_mov_b64 exec, s[40:41]
    ds_add_rtn_u32 v28, v3, v3 offset:12
    v_lshrrev_b32 v29, 2, v0
    v_add_u32 v29, 0, v29
    s_waitcnt lgkmcnt(0)
    ds_write_b32 v28, v29 offset:64
    s_mov_b64 exec, s[42:43]
    ds_add_rtn_u32 v28, v3, v3 offset:12
    v_lshrrev_b32_e64 v29, 2, v0
    v_add_u32 v29, 64, v29
    s_waitcnt lgkmcnt(0)
    ds_write_b32 v28, v29 offset:64
    s_mov_b64 exec, -1
    s_branch L_marked
L_rescan:
    s_mov_b32 s91, s3
    s_mov_b32 s44, 0
L_rescan_loop:
    s_and_b32 s3, s44, -4
    v_mov_b32 v50, s3
    ds_read_b32 v50, v50 offset:64
    s_and_b32 s3, s44, KC_2-KC_Z
    s_lshl_b32 s3, s3, 1
    s_add_u32 s3, s3, s36
    s_mul_i32 s3, s3, 640
    v_lshl_add_u32 v51, v1, 4, s3
    s_movk_i32 s3, 5120
    s_waitcnt lgkmcnt(0)
    v_min_u32 v50, 124, v50
    v_mad_u32_u24 v51, v50, s3, v51
    v_bfrev_b32 v49, 1
    v_mov_b32 v20, v49
    v_mov_b32 v21, v49
    v_mov_b32 v22, v49
    v_mov_b32 v23, v49
    s_movk_i32 exec_hi, 0xff
    global_load_dwordx4 v[40:43], v51, s[8:9]
    global_load_dwordx4 v[44:47], v51, s[6:7]
    s_mov_b32 s60, 0x8000000c
    s_brev_b32 s61, 1
    s_waitcnt vmcnt(0)
    v_and_b32 v48, 0xff, v40
    v_cmp_eq_u32 vcc, s56, v48
    v_lshrrev_b32 v40, 8, v40
    v_lshlrev_b32_e64 v40, 2, v40
    v_lshl_or_b32 v40, v44, 9, v40
    v_cndmask_b32_e64 v20, v49, v40, vcc
    v_and_b32 v48, 0xff, v41
    v_cmp_eq_u32 vcc, s56, v48
    v_lshrrev_b32 v41, 8, v41
    v_lshlrev_b32_e64 v41, 2, v41
    v_lshl_or_b32 v41, v45, 9, v41
    v_cndmask_b32_e64 v21, v49, v41, vcc
    v_and_b32 v48, 0xff, v42
    v_cmp_eq_u32 vcc, s56, v48
    v_lshrrev_b32 v42, 8, v42
    v_lshlrev_b32_e64 v42, 2, v42
    v_lshl_or_b32 v42, v46, 9, v42
    v_cndmask_b32_e64 v22, v49, v42, vcc
    v_and_b32 v48, 0xff, v43
    v_cmp_eq_u32 vcc, s56, v48
    v_lshrrev_b32 v43, 8, v43
    v_lshlrev_b32_e64 v43, 2, v43
    v_lshl_or_b32 v43, v47, 9, v43
    v_cndmask_b32 v23, v49, v43, vcc
    s_mov_b64 exec, -1
    v_and_b32_e64 v28, s60, v20
    ds_add_rtn_u32 v28, v28, v3
    v_and_b32_e64 v29, s60, v21
    ds_add_rtn_u32 v29, v29, v3
    v_and_b32_e64 v30, s60, v22
    ds_add_rtn_u32 v30, v30, v3
    v_and_b32_e64 v31, s60, v23
    ds_add_rtn_u32 v31, v31, v3
    s_waitcnt lgkmcnt(3)
    v_and_or_b32 v28, v20, s61, v28
    ds_write_b32 v28, v20
    s_waitcnt lgkmcnt(3)
    v_and_or_b32 v29, v21, s61, v29
    ds_write_b32 v29, v21
    s_waitcnt lgkmcnt(3)
    v_and_or_b32 v30, v22, s61, v30
    ds_write_b32 v30, v22
    s_waitcnt lgkmcnt(3)
    v_and_or_b32 v31, v23, s61, v31
    ds_write_b32 v31, v23
    s_add_u32 s44, s44, 2
    s_cmp_lt_u32 s44, s91
    s_cbranch_scc1 L_rescan_loop
    s_waitcnt lgkmcnt(0)
    s_barrier
    s_branch L_lists
    s_nop 0
L_goslow:
    s_mov_b32 s39, 0
L_slow:
    s_mov_b32 s91, 0
    s_waitcnt vmcnt(0) lgkmcnt(0)
    s_barrier
    s_barrier
L_scan:
    s_lshl_b32 s3, s36, 8
    s_add_u32 s3, s3, s39
    v_lshl_add_u32 v51, v1, 4, s3
    v_bfrev_b32 v49, 1
    v_mov_b32 v20, v49
    v_mov_b32 v21, v49
    v_mov_b32 v22, v49
    v_mov_b32_e64 v23, v49
    s_mov_b64 exec, 0xffff
    global_load_dwordx4 v[40:43], v51, s[8:9]
    global_load_dwordx4 v[44:47], v51, s[6:7]
    s_mov_b32 s60, 0x8000000c
    s_brev_b32 s61, 1
    s_waitcnt vmcnt(0)
    v_and_b32 v48, 0xff, v40
    v_cmp_eq_u32 vcc, s56, v48
    v_lshrrev_b32 v40, 8, v40
    v_lshlrev_b32_e64 v40, 2, v40
    v_lshl_or_b32 v40, v44, 9, v40
    v_cndmask_b32_e64 v20, v49, v40, vcc
    v_and_b32 v48, 0xff, v41
    v_cmp_eq_u32 vcc, s56, v48
    v_lshrrev_b32 v41, 8, v41
    v_lshlrev_b32_e64 v41, 2, v41
    v_lshl_or_b32 v41, v45, 9, v41
    v_cndmask_b32_e64 v21, v49, v41, vcc
    v_and_b32 v48, 0xff, v42
    v_cmp_eq_u32 vcc, s56, v48
    v_lshrrev_b32 v42, 8, v42
    v_lshlrev_b32_e64 v42, 2, v42
    v_lshl_or_b32 v42, v46, 9, v42
    v_cndmask_b32_e64 v22, v49, v42, vcc
    v_and_b32 v48, 0xff, v43
    v_cmp_eq_u32 vcc, s56, v48
    v_lshrrev_b32 v43, 8, v43
    v_lshlrev_b32_e64 v43, 2, v43
    v_lshl_or_b32 v43, v47, 9, v43
    v_cndmask_b32 v23, v49, v43, vcc
    s_mov_b64 exec, -1
    v_and_b32_e64 v28, s60, v20
    ds_add_rtn_u32 v28, v28, v3
    v_and_b32_e64 v29, s60, v21
    ds_add_rtn_u32 v29, v29, v3
    v_and_b32_e64 v30, s60, v22
    ds_add_rtn_u32 v30, v30, v3
    v_and_b32_e64 v31, s60, v23
    ds_add_rtn_u32 v31, v31, v3
    s_waitcnt lgkmcnt(3)
    v_and_or_b32 v28, v20, s61, v28
    ds_write_b32 v28, v20
    s_waitcnt lgkmcnt(3)
    v_and_or_b32 v29, v21, s61, v29
    ds_write_b32 v29, v21
    s_waitcnt lgkmcnt(3)
    v_and_or_b32 v30, v22, s61, v30
    ds_write_b32 v30, v22
    s_waitcnt lgkmcnt(3)
    v_and_or_b32 v31, v23, s61, v31
    ds_write_b32 v31, v23
    s_add_u32 s39, s39, 1024
    s_waitcnt lgkmcnt(0)
    s_barrier
    ds_read_b32 v5, v4
    s_waitcnt lgkmcnt(0)
    s_barrier
    v_sub_u32 v6, v5, v252
    v_lshrrev_b32 v6, 6, v6
    v_max_u32_e64 v6, 4, v6
    v_readlane_b32 s3, v5, 5
    v_readlane_b32 s37, v6, s93
    v_readlane_b32 s38, v6, 0
    v_readlane_b32 s60, v6, 1
    v_readlane_b32 s61, v6, 2
    s_or_b32 s63, s63, s3
    s_max_u32 s38, s38, s60
    v_readlane_b32 s60, v6, 3
    s_max_u32 s38, s38, s61
    s_lshl_b32 s3, s3, 8
    s_max_u32 s38, s38, s60
    s_or_b32 s3, s3, s38
    s_cmp_gt_u32 s3, 30
    s_cmp_ge_u32 s39, 640000
    s_cbranch_scc1 L_scanned
    s_cmp_le_u32 s38, 14
    s_cbranch_scc1 L_scan
L_scanned:
    s_mul_i32 s3, s93, 2016
    s_add_u32 s3, s3, 155648
    v_and_b32 v6, 32, v1
    v_add_u32 v228, s3, v6
    s_mov_b32 s45, KC_0-KC_Z
    buffer_load_dwordx4 v[68:71], v2, s[24:27], s45 offen offset:0
    buffer_load_dwordx4 v[72:75], v2, s[24:27], s45 offen offset:512
    buffer_load_dwordx4 v[76:79], v2, s[24:27], s45 offen offset:1024
    buffer_load_dwordx4 v[80:83], v2, s[24:27], s45 offen offset:1536
    s_mov_b32 s45, 16384
    buffer_load_dwordx4 v[84:87], v2, s[24:27], s45 offen offset:0
    buffer_load_dwordx4 v[88:91], v2, s[24:27], s45 offen offset:512
    buffer_load_dwordx4 v[92:95], v2, s[24:27], s45 offen offset:1024
    buffer_load_dwordx4 v[96:99], v2, s[24:27], s45 offen offset:1536
    s_mov_b32 s45, 32768
    buffer_load_dwordx4 v[100:103], v2, s[24:27], s45 offen offset:0
    buffer_load_dwordx4 v[104:107], v2, s[24:27], s45 offen offset:512
    buffer_load_dwordx4 v[108:111], v2, s[24:27], s45 offen offset:1024
    buffer_load_dwordx4 v[112:115], v2, s[24:27], s45 offen offset:1536
    s_waitcnt vmcnt(0)
    s_branch L_lists
    s_nop 0
C_marks:
    s_barrier
    ds_read_b32 v252, v251
    s_waitcnt lgkmcnt(0)
    v_sub_u32 v253, v252, v254
    v_lshrrev_b32 v253, 6, v253
    v_max_u32 v253, 4, v253
    v_readlane_b32 s3, v252, 5
    v_readlane_b32 s37, v253, s93
    v_readlane_b32 s38, v253, 0
    v_readlane_b32 s60, v253, 1
    v_readlane_b32 s61, v253, 2
    s_or_b32 s63, s63, s3
    s_max_u32 s38, s38, s60
    v_readlane_b32 s60, v253, 3
    s_max_u32 s38, s38, s61
    s_lshl_b32 s3, s3, 8
    s_max_u32 s38, s38, s60
    s_or_b32 s3, s3, s38
    s_cmp_gt_u32 s3, 30
    s_branch C_counted
    s_nop 0
C_goslow:
    s_mov_b32 s39, 0
    s_waitcnt lgkmcnt(0)
C_slow:
    s_barrier
    v_mov_b32 v228, 8388351
    v_mov_b32 v229, v228
    v_mov_b32 v230, v228
    v_mov_b32_e64 v231, v228
    s_mov_b32 s3, 151552
    v_lshl_add_u32 v253, v0, 4, s3
    ds_write_b128 v253, v[228:231]
    ds_write_b128 v253, v[228:231] offset:4096
    v_cmp_gt_u32 vcc, 4, v1
    v_add_u32 v253, 60, v254
    v_lshlrev_b32 v251, 2, v1
    v_cndmask_b32 v253, 0, v253, vcc
    s_mov_b64 exec, 0xff
    ds_write_b32 v251, v253
    s_mov_b64 exec, -1
    s_waitcnt lgkmcnt(0)
    s_barrier
C_scan:
    s_add_u32 s39, s39, 1024
    s_barrier
    ds_read_b32 v252, v251
    s_waitcnt lgkmcnt(0)
    s_barrier
    v_sub_u32 v253, v252, v254
    v_lshrrev_b32 v253, 6, v253
    v_max_u32_e64 v253, 4, v253
    v_readlane_b32 s3, v252, 5
    v_readlane_b32 s37, v253, s93
    v_readlane_b32 s38, v253, 0
    v_readlane_b32 s60, v253, 1
    v_readlane_b32 s61, v253, 2
    s_or_b32 s63, s63, s3
    s_max_u32 s38, s38, s60
    v_readlane_b32 s60, v253, 3
    s_max_u32 s38, s38, s61
    s_lshl_b32 s3, s3, 8
    s_max_u32 s38, s38, s60
    s_or_b32 s3, s3, s38
    s_cmp_gt_u32 s3, KC_30-KC_Z
    s_cmp_ge_u32 s39, 640000
    s_cbranch_scc1 C_enter
    s_cmp_le_u32 s38, 14
    s_cbranch_scc1 C_scan
    s_branch C_enter
K_done:
    s_endpgm
.set KC_0, 0
.set KC_1, 1
.set KC_2, 2
.set KC_4, 4
.set KC_6, 6
.set KC_7, 7
.set KC_8, 8
.set KC_9, 9
.set KC_30, 30
.set KC_Z, 0
.section .rodata,"a"
.p2align 6
.amdhsa_kernel standalone__kernel_systems_refs_featgraph__graph_kernel
  .amdhsa_next_free_vgpr 256
  .amdhsa_next_free_sgpr 102
  .amdhsa_accum_offset 256
  .amdhsa_group_segment_fixed_size 0
  .amdhsa_kernarg_size 64
  .amdhsa_user_sgpr_count 2
  .amdhsa_user_sgpr_kernarg_segment_ptr 1
  .amdhsa_system_sgpr_workgroup_id_x 1
  .amdhsa_float_denorm_mode_32 3
.end_amdhsa_kernel
```
